```python
import torch

def _softmax(x, axis=-1):
    return torch.softmax(x, dim=axis)

def _gelu(x):
    return torch.nn.functional.gelu(x, approximate='tanh')

def _silu(x):
    return torch.nn.functional.silu(x)

def _sigmoid(x):
    return torch.sigmoid(x)

def _layernorm(x, axis=-1, eps=1e-05):
    m = x.mean(dim=axis, keepdim=True)
    v = x.var(dim=axis, keepdim=True, unbiased=False)
    return (x - m) / torch.sqrt(v + eps)

def _scatter_add(tgt, idx, src, axis=0):
    return tgt.clone().index_add_(axis, idx, src)

def _segment_sum(src, seg, n):
    out = torch.zeros((n,) + src.shape[1:], dtype=src.dtype)
    return out.index_add_(0, seg, src)

def _pad(x, pw):
    flat = tuple((v for pair in reversed(pw) for v in pair))
    return torch.nn.functional.pad(x, flat)
kernel_name = 'standalone__conformer_conv_module__speech'

def setup_inputs():

    _w = lambda a: (lambda t: t.to(torch.bfloat16) if t.is_floating_point() else t)(torch.as_tensor(a))
    B, T, D, K = (2, 16000, 256, 15)
    return {'x': _w((lambda *s: torch.randn(*s, dtype=torch.bfloat16) * 0.2)(B, T, D)), 'w_pw1': _w((lambda *s: torch.randn(*s, dtype=torch.bfloat16) * 0.2)(D, 2 * D)), 'dw': _w((lambda *s: torch.randn(*s, dtype=torch.bfloat16) * 0.2)(K, D)), 'w_pw2': _w((lambda *s: torch.randn(*s, dtype=torch.bfloat16) * 0.05)(D, D))}

def reference(x, w_pw1, dw, w_pw2):
    B, T, D = x.shape
    K = dw.shape[0]
    h = x @ w_pw1
    a, b = (h[..., :D].clone(), h[..., D:].clone())
    h = a * _sigmoid(b)
    pad = K // 2
    hp = _pad(h, ((0, 0), (pad, pad), (0, 0)))
    out = torch.zeros_like(h)
    for i in range(K):
        out = out + hp[:, i:i + T, :] * dw[i][None, None, :]
    return _silu(out) @ w_pw2
```

```asm
; @launch grid=(256,1,1) block=(512,1,1) lds=162816
.amdgcn_target "amdgcn-amd-amdhsa--gfx950"
.text
.globl standalone__conformer_conv_module__speech_kernel
.p2align 8
.type standalone__conformer_conv_module__speech_kernel,@function
standalone__conformer_conv_module__speech_kernel:
s_cmp_ge_u32 s2, 0x100
s_cbranch_scc1 L_done
s_load_dwordx8 s[4:11], s[0:1], 0
s_load_dwordx2 s[12:13], s[0:1], 32
v_lshrrev_b32 v1, 6, v0
v_and_b32 v0, 63, v0
v_readfirstlane_b32 s36, v1
v_lshrrev_b32 v2, 5, v0
v_and_b32 v3, 31, v0
v_lshrrev_b32 v10, 2, v0
v_and_b32 v8, 3, v0
s_lshr_b32 s46, s2, 7
s_and_b32 s47, s2, 127
s_mul_i32 s39, s47, 64000
s_sub_u32 s39, s39, 12800
s_mul_i32 s46, s46, 8192000
s_mul_i32 s47, s2, 64000
s_and_b32 s48, s36, 3
s_mul_i32 s40, s48, 1040
s_lshl_b32 s48, s48, 9
s_lshl_b32 s41, s36, 10
s_add_u32 s41, s41, 66560
s_mul_i32 s45, s36, 3072
s_add_u32 s45, s45, 115712
s_lshl_b32 s49, s36, 6
s_lshr_b32 s100, s2, 1
s_and_b32 s100, s100, 124
s_and_b32 s3, s36, 3
s_add_u32 s100, s100, s3
s_mov_b32 s37, 0xbfb8aa3b
s_mov_b32 s38, 0xbf317218
v_lshl_add_u32 v4, v2, 13, s48
v_lshl_add_u32 v255, v3, 4, v4
v_lshl_add_u32 v11, v8, 4, s49
v_lshl_add_u32 v184, v10, 10, v11
v_lshl_add_u32 v191, v10, 9, v11
s_mov_b32 s18, 8192000
s_mov_b32 s19, 0x20000
s_mov_b32 s22, 262144
s_mov_b32 s23, 0x20000
s_mov_b32 s26, 131072
s_mov_b32 s27, 0x20000
s_mov_b32 s30, 7680
s_mov_b32 s31, 0x20000
s_mov_b32 s34, 64000
s_mov_b32 s35, 0x20000
s_cmp_lt_u32 s36, 4
s_cbranch_scc0 L_late
v_add_u32 v176, s39, v255
s_add_u32 s44, s39, 4096
v_add_u32 v177, s44, v255
s_add_u32 s42, s39, 2048
v_add_u32 v178, s42, v255
s_add_u32 s43, s39, 6144
v_add_u32 v179, s43, v255
s_waitcnt lgkmcnt(0)
s_add_u32 s16, s4, s46
s_addc_u32 s17, s5, 0
s_mov_b32 s20, s6
s_mov_b32 s21, s7
s_mov_b32 s28, s8
s_mov_b32 s29, s9
s_mov_b32 s24, s10
s_mov_b32 s25, s11
s_add_u32 s32, s12, s47
s_addc_u32 s33, s13, 0
s_mov_b32 m0, s41
s_nop 0
buffer_load_dwordx4 v184, s[20:23], 0 offen lds
s_add_u32 m0, s41, 8192
s_mov_b32 s44, 512
buffer_load_dwordx4 v184, s[20:23], s44 offen lds
s_lshl_b32 s42, s36, 11
s_add_u32 m0, s42, 49984
s_nop 0
buffer_load_dwordx4 v191, s[28:31], 0 offen lds
s_mov_b32 exec_lo, 0
s_mov_b32 m0, s40
s_nop 0
buffer_load_dwordx4 v176, s[16:19], 0 offen nt lds
s_add_u32 m0, s40, 4160
s_nop 0
buffer_load_dwordx4 v177, s[16:19], 0 offen nt lds
s_add_u32 m0, s40, 8320
s_nop 0
buffer_load_dwordx4 v178, s[16:19], 0 offen nt lds
s_add_u32 m0, s40, 12480
s_nop 0
buffer_load_dwordx4 v179, s[16:19], 0 offen nt lds
s_mov_b32 exec_lo, -1
s_add_u32 m0, s40, 16640
s_add_u32 s43, s39, 16384
buffer_load_dwordx4 v255, s[16:19], s43 offen nt lds
s_add_u32 m0, s40, 20800
s_add_u32 s44, s39, 20480
buffer_load_dwordx4 v255, s[16:19], s44 offen nt lds
s_add_u32 m0, s40, 24960
s_add_u32 s42, s39, 18432
buffer_load_dwordx4 v255, s[16:19], s42 offen nt lds
s_add_u32 m0, s40, 29120
s_add_u32 s43, s39, 22528
buffer_load_dwordx4 v255, s[16:19], s43 offen nt lds
v_and_b32 v5, 15, v0
v_bfe_u32 v6, v0, 4, 1
v_mul_u32_u24 v248, 0x410, v5
v_lshl_add_u32 v248, v6, 9, v248
v_lshl_add_u32 v248, v2, 4, v248
v_lshrrev_b32 v7, 2, v5
v_lshlrev_b32 v9, 9, v2
v_lshl_add_u32 v9, v7, 6, v9
v_lshl_add_u32 v9, v6, 5, v9
v_lshl_add_u32 v12, v8, 3, v9
v_add_u32 v252, 0x10400, v12
v_add_u32 v185, s41, v12
v_add_u32 v160, s45, v12
s_lshl_b32 s48, s36, 11
s_add_u32 s48, s48, 49920
v_add_u32 v186, s48, v12
v_and_b32 v13, 1, v0
v_lshl_add_u32 v13, v13, 4, v9
v_bfe_u32 v14, v0, 1, 1
v_lshl_add_u32 v13, v14, 3, v13
v_add_u32 v189, s41, v13
v_lshl_add_u32 v251, v0, 4, s41
v_lshrrev_b32 v13, 1, v3
v_lshrrev_b32 v14, 2, v3
v_xor_b32 v13, v13, v14
v_and_b32 v13, 1, v13
v_xor_b32 v13, v13, v3
v_mul_u32_u24 v13, 0x60, v13
v_lshl_add_u32 v13, v2, 4, v13
v_add_u32 v249, s45, v13
v_lshrrev_b32 v13, 1, v10
v_lshrrev_b32 v14, 2, v10
v_xor_b32 v13, v13, v14
v_and_b32 v13, 1, v13
v_xor_b32 v13, v13, v10
v_mul_u32_u24 v13, 0x60, v13
v_lshl_add_u32 v13, v8, 4, v13
v_add_u32 v250, s45, v13
s_mul_i32 s48, s36, 2816
s_add_u32 s48, s48, 140288
v_mul_u32_u24 v13, 0xb0, v10
v_lshlrev_b32 v14, 2, v8
v_sub_u32 v13, v13, v14
v_add3_u32 v253, v13, s48, 12
v_mul_u32_u24 v13, 0xb0, v5
v_add_u32 v13, s48, v13
v_mul_u32_u24 v14, 0x50, v6
v_lshl_add_u32 v161, v2, 5, v14
v_add3_u32 v161, v161, v13, 16
v_mul_u32_u24 v15, 0xa0, v2
v_max_u32 v14, v14, v15
v_add_u32 v162, v13, v14
s_lshl_b32 s48, s36, 11
s_add_u32 s48, s48, 49920
v_lshl_add_u32 v14, v8, 4, s48
v_cmp_lt_u32 vcc, 47, v0
s_nop 1
v_cndmask_b32 v162, v162, v14, vcc
v_lshl_add_u32 v13, v2, 4, s49
v_lshl_add_u32 v13, v6, 5, v13
v_lshl_add_u32 v254, v5, 9, v13
v_mov_b32 v164, 0
v_mov_b32 v165, 0
v_mov_b32 v166, 0
v_mov_b32 v167, 0
s_lshl_b32 s46, s36, 12
s_add_u32 s46, s46, 16640
s_sub_u32 s47, s46, s41
v_add_u32 v190, s47, v189
s_mov_b32 m0, s45
s_mov_b32 s44, 16384
buffer_load_dwordx4 v184, s[20:23], s44 offen lds
s_add_u32 m0, s45, 1024
s_mov_b32 s42, 16896
buffer_load_dwordx4 v184, s[20:23], s42 offen lds
s_add_u32 m0, s45, 2048
s_mov_b32 s43, 32768
buffer_load_dwordx4 v184, s[20:23], s43 offen lds
s_add_u32 m0, s41, 32768
s_mov_b32 s44, 33280
buffer_load_dwordx4 v184, s[20:23], s44 offen lds
s_add_u32 m0, s41, 40960
s_mov_b32 s42, 49152
buffer_load_dwordx4 v184, s[20:23], s42 offen lds
s_add_u32 m0, s41, 16384
s_mov_b32 s43, 49664
buffer_load_dwordx4 v184, s[20:23], s43 offen lds
s_add_u32 m0, s41, 24576
s_mov_b32 s44, 65536
buffer_load_dwordx4 v184, s[20:23], s44 offen lds
s_waitcnt vmcnt(16)
ds_read_b64_tr_b16 v[0:1], v185
ds_read_b64_tr_b16 v[2:3], v185 offset:256
ds_read_b64_tr_b16 v[4:5], v185 offset:8192
ds_read_b64_tr_b16 v[6:7], v185 offset:8448
ds_write_b128 v162, v[164:167]
s_waitcnt vmcnt(15)
ds_read_b64_tr_b16 v[168:169], v186
ds_read_b64_tr_b16 v[170:171], v186 offset:64
ds_read_b64_tr_b16 v[172:173], v186 offset:256
ds_read_b64_tr_b16 v[174:175], v186 offset:320
s_waitcnt lgkmcnt(2)
v_swap_b32 v169, v170
s_waitcnt lgkmcnt(0)
v_swap_b32 v173, v174
ds_write_b128 v161, v[168:171]
ds_write_b128 v161, v[172:175] offset:16
s_waitcnt vmcnt(7)
s_barrier
s_setprio 3
ds_read_b128 v[224:227], v248
ds_read_b128 v[228:231], v248 offset:16640
s_waitcnt vmcnt(5)
ds_read_b64_tr_b16 v[8:9], v160
ds_read_b64_tr_b16 v[10:11], v160 offset:256
ds_read_b64_tr_b16 v[12:13], v160 offset:1024
ds_read_b64_tr_b16 v[14:15], v160 offset:1280
ds_read_b128 v[232:235], v248 offset:32
ds_read_b128 v[236:239], v248 offset:16672
s_mov_b32 m0, s41
s_mov_b32 s42, 66048
buffer_load_dwordx4 v184, s[20:23], s42 offen lds
s_add_u32 m0, s41, 8192
s_mov_b32 s43, 81920
buffer_load_dwordx4 v184, s[20:23], s43 offen lds
s_waitcnt lgkmcnt(7)
v_mfma_f32_32x32x16_bf16 v[128:143], v[224:227], v[0:3], 0
s_waitcnt lgkmcnt(2)
s_mov_b32 m0, s45
s_mov_b32 s44, 82432
buffer_load_dwordx4 v184, s[20:23], s44 offen lds
v_mfma_f32_32x32x16_bf16 v[144:159], v[224:227], v[4:7], 0
s_add_u32 m0, s45, 1024
s_mov_b32 s42, 98304
buffer_load_dwordx4 v184, s[20:23], s42 offen lds
v_mfma_f32_32x32x16_bf16 v[192:207], v[228:231], v[0:3], 0
s_waitcnt vmcnt(7)
ds_read_b64_tr_b16 v[16:17], v160 offset:2048
ds_read_b64_tr_b16 v[18:19], v160 offset:2304
ds_read_b64_tr_b16 v[20:21], v185 offset:32768
ds_read_b64_tr_b16 v[22:23], v185 offset:33024
v_mfma_f32_32x32x16_bf16 v[208:223], v[228:231], v[4:7], 0
ds_read_b128 v[240:243], v248 offset:64
ds_read_b128 v[244:247], v248 offset:16704
s_waitcnt lgkmcnt(7)
v_mfma_f32_32x32x16_bf16 v[128:143], v[232:235], v[8:11], v[128:143]
s_waitcnt lgkmcnt(2)
s_add_u32 m0, s45, 2048
s_mov_b32 s43, 98816
buffer_load_dwordx4 v184, s[20:23], s43 offen lds
v_mfma_f32_32x32x16_bf16 v[144:159], v[232:235], v[12:15], v[144:159]
s_add_u32 m0, s41, 32768
s_mov_b32 s44, 114688
buffer_load_dwordx4 v184, s[20:23], s44 offen lds
v_mfma_f32_32x32x16_bf16 v[192:207], v[236:239], v[8:11], v[192:207]
s_waitcnt vmcnt(7)
ds_read_b64_tr_b16 v[24:25], v185 offset:40960
ds_read_b64_tr_b16 v[26:27], v185 offset:41216
ds_read_b64_tr_b16 v[28:29], v185 offset:16384
ds_read_b64_tr_b16 v[30:31], v185 offset:16640
v_mfma_f32_32x32x16_bf16 v[208:223], v[236:239], v[12:15], v[208:223]
ds_read_b128 v[224:227], v248 offset:96
ds_read_b128 v[228:231], v248 offset:16736
s_waitcnt lgkmcnt(7)
v_mfma_f32_32x32x16_bf16 v[128:143], v[240:243], v[16:19], v[128:143]
s_waitcnt lgkmcnt(2)
s_add_u32 m0, s41, 40960
s_mov_b32 s42, 115200
buffer_load_dwordx4 v184, s[20:23], s42 offen lds
v_mfma_f32_32x32x16_bf16 v[144:159], v[240:243], v[20:23], v[144:159]
s_add_u32 m0, s41, 16384
s_mov_b32 s43, 131072
buffer_load_dwordx4 v184, s[20:23], s43 offen lds
v_mfma_f32_32x32x16_bf16 v[192:207], v[244:247], v[16:19], v[192:207]
s_waitcnt vmcnt(7)
ds_read_b64_tr_b16 v[32:33], v185 offset:24576
ds_read_b64_tr_b16 v[34:35], v185 offset:24832
ds_read_b64_tr_b16 v[36:37], v185
ds_read_b64_tr_b16 v[38:39], v185 offset:256
v_mfma_f32_32x32x16_bf16 v[208:223], v[244:247], v[20:23], v[208:223]
ds_read_b128 v[232:235], v248 offset:128
ds_read_b128 v[236:239], v248 offset:16768
s_waitcnt lgkmcnt(7)
v_mfma_f32_32x32x16_bf16 v[128:143], v[224:227], v[24:27], v[128:143]
s_waitcnt lgkmcnt(2)
s_add_u32 m0, s41, 24576
s_mov_b32 s44, 131584
buffer_load_dwordx4 v184, s[20:23], s44 offen lds
v_mfma_f32_32x32x16_bf16 v[144:159], v[224:227], v[28:31], v[144:159]
s_mov_b32 m0, s41
s_mov_b32 s42, 147456
buffer_load_dwordx4 v184, s[20:23], s42 offen lds
v_mfma_f32_32x32x16_bf16 v[192:207], v[228:231], v[24:27], v[192:207]
s_waitcnt vmcnt(7)
ds_read_b64_tr_b16 v[40:41], v185 offset:8192
ds_read_b64_tr_b16 v[42:43], v185 offset:8448
ds_read_b64_tr_b16 v[44:45], v160
ds_read_b64_tr_b16 v[46:47], v160 offset:256
v_mfma_f32_32x32x16_bf16 v[208:223], v[228:231], v[28:31], v[208:223]
ds_read_b128 v[240:243], v248 offset:160
ds_read_b128 v[244:247], v248 offset:16800
s_waitcnt lgkmcnt(7)
v_mfma_f32_32x32x16_bf16 v[128:143], v[232:235], v[32:35], v[128:143]
s_waitcnt lgkmcnt(2)
s_add_u32 m0, s41, 8192
s_mov_b32 s43, 147968
buffer_load_dwordx4 v184, s[20:23], s43 offen lds
v_mfma_f32_32x32x16_bf16 v[144:159], v[232:235], v[36:39], v[144:159]
s_mov_b32 m0, s45
s_mov_b32 s44, 163840
buffer_load_dwordx4 v184, s[20:23], s44 offen lds
v_mfma_f32_32x32x16_bf16 v[192:207], v[236:239], v[32:35], v[192:207]
s_waitcnt vmcnt(7)
ds_read_b64_tr_b16 v[48:49], v160 offset:1024
ds_read_b64_tr_b16 v[50:51], v160 offset:1280
ds_read_b64_tr_b16 v[52:53], v160 offset:2048
ds_read_b64_tr_b16 v[54:55], v160 offset:2304
v_mfma_f32_32x32x16_bf16 v[208:223], v[236:239], v[36:39], v[208:223]
ds_read_b128 v[224:227], v248 offset:192
ds_read_b128 v[228:231], v248 offset:16832
s_waitcnt lgkmcnt(7)
v_mfma_f32_32x32x16_bf16 v[128:143], v[240:243], v[40:43], v[128:143]
s_waitcnt lgkmcnt(2)
s_add_u32 m0, s45, 1024
s_mov_b32 s42, 164352
buffer_load_dwordx4 v184, s[20:23], s42 offen lds
v_mfma_f32_32x32x16_bf16 v[144:159], v[240:243], v[44:47], v[144:159]
s_add_u32 m0, s45, 2048
s_mov_b32 s43, 180224
buffer_load_dwordx4 v184, s[20:23], s43 offen lds
v_mfma_f32_32x32x16_bf16 v[192:207], v[244:247], v[40:43], v[192:207]
s_waitcnt vmcnt(7)
ds_read_b64_tr_b16 v[56:57], v185 offset:32768
ds_read_b64_tr_b16 v[58:59], v185 offset:33024
ds_read_b64_tr_b16 v[60:61], v185 offset:40960
ds_read_b64_tr_b16 v[62:63], v185 offset:41216
v_mfma_f32_32x32x16_bf16 v[208:223], v[244:247], v[44:47], v[208:223]
ds_read_b128 v[232:235], v248 offset:224
ds_read_b128 v[236:239], v248 offset:16864
s_waitcnt lgkmcnt(7)
v_mfma_f32_32x32x16_bf16 v[128:143], v[224:227], v[48:51], v[128:143]
s_waitcnt lgkmcnt(2)
s_add_u32 m0, s41, 32768
s_mov_b32 s44, 180736
buffer_load_dwordx4 v184, s[20:23], s44 offen lds
v_mfma_f32_32x32x16_bf16 v[144:159], v[224:227], v[52:55], v[144:159]
s_add_u32 m0, s41, 40960
s_mov_b32 s42, 196608
buffer_load_dwordx4 v184, s[20:23], s42 offen lds
v_mfma_f32_32x32x16_bf16 v[192:207], v[228:231], v[48:51], v[192:207]
s_waitcnt vmcnt(7)
ds_read_b64_tr_b16 v[64:65], v185 offset:16384
ds_read_b64_tr_b16 v[66:67], v185 offset:16640
ds_read_b64_tr_b16 v[68:69], v185 offset:24576
ds_read_b64_tr_b16 v[70:71], v185 offset:24832
v_mfma_f32_32x32x16_bf16 v[208:223], v[228:231], v[52:55], v[208:223]
ds_read_b128 v[240:243], v248 offset:256
ds_read_b128 v[244:247], v248 offset:16896
s_waitcnt lgkmcnt(7)
v_mfma_f32_32x32x16_bf16 v[128:143], v[232:235], v[56:59], v[128:143]
s_waitcnt lgkmcnt(2)
s_add_u32 m0, s41, 16384
s_mov_b32 s43, 197120
buffer_load_dwordx4 v184, s[20:23], s43 offen lds
v_mfma_f32_32x32x16_bf16 v[144:159], v[232:235], v[60:63], v[144:159]
s_add_u32 m0, s41, 24576
s_mov_b32 s44, 212992
buffer_load_dwordx4 v184, s[20:23], s44 offen lds
v_mfma_f32_32x32x16_bf16 v[192:207], v[236:239], v[56:59], v[192:207]
s_waitcnt vmcnt(7)
ds_read_b64_tr_b16 v[72:73], v185
ds_read_b64_tr_b16 v[74:75], v185 offset:256
ds_read_b64_tr_b16 v[76:77], v185 offset:8192
ds_read_b64_tr_b16 v[78:79], v185 offset:8448
v_mfma_f32_32x32x16_bf16 v[208:223], v[236:239], v[60:63], v[208:223]
ds_read_b128 v[224:227], v248 offset:288
ds_read_b128 v[228:231], v248 offset:16928
s_waitcnt lgkmcnt(7)
v_mfma_f32_32x32x16_bf16 v[128:143], v[240:243], v[64:67], v[128:143]
s_waitcnt lgkmcnt(2)
s_mov_b32 m0, s41
s_mov_b32 s42, 213504
buffer_load_dwordx4 v184, s[20:23], s42 offen lds
v_mfma_f32_32x32x16_bf16 v[144:159], v[240:243], v[68:71], v[144:159]
s_add_u32 m0, s41, 8192
s_mov_b32 s43, 229376
buffer_load_dwordx4 v184, s[20:23], s43 offen lds
v_mfma_f32_32x32x16_bf16 v[192:207], v[244:247], v[64:67], v[192:207]
s_waitcnt vmcnt(7)
ds_read_b64_tr_b16 v[80:81], v160
ds_read_b64_tr_b16 v[82:83], v160 offset:256
ds_read_b64_tr_b16 v[84:85], v160 offset:1024
ds_read_b64_tr_b16 v[86:87], v160 offset:1280
v_mfma_f32_32x32x16_bf16 v[208:223], v[244:247], v[68:71], v[208:223]
ds_read_b128 v[232:235], v248 offset:320
ds_read_b128 v[236:239], v248 offset:16960
s_waitcnt lgkmcnt(7)
v_mfma_f32_32x32x16_bf16 v[128:143], v[224:227], v[72:75], v[128:143]
s_waitcnt lgkmcnt(2)
s_mov_b32 m0, s45
s_mov_b32 s44, 229888
buffer_load_dwordx4 v184, s[20:23], s44 offen lds
v_mfma_f32_32x32x16_bf16 v[144:159], v[224:227], v[76:79], v[144:159]
s_add_u32 m0, s45, 1024
s_mov_b32 s42, 245760
buffer_load_dwordx4 v184, s[20:23], s42 offen lds
v_mfma_f32_32x32x16_bf16 v[192:207], v[228:231], v[72:75], v[192:207]
s_waitcnt vmcnt(7)
ds_read_b64_tr_b16 v[88:89], v160 offset:2048
ds_read_b64_tr_b16 v[90:91], v160 offset:2304
ds_read_b64_tr_b16 v[92:93], v185 offset:32768
ds_read_b64_tr_b16 v[94:95], v185 offset:33024
v_mfma_f32_32x32x16_bf16 v[208:223], v[228:231], v[76:79], v[208:223]
ds_read_b128 v[240:243], v248 offset:352
ds_read_b128 v[244:247], v248 offset:16992
s_waitcnt lgkmcnt(7)
v_mfma_f32_32x32x16_bf16 v[128:143], v[232:235], v[80:83], v[128:143]
s_waitcnt lgkmcnt(2)
s_add_u32 m0, s45, 2048
s_mov_b32 s43, 246272
buffer_load_dwordx4 v184, s[20:23], s43 offen lds
v_mfma_f32_32x32x16_bf16 v[144:159], v[232:235], v[84:87], v[144:159]
s_barrier
v_mfma_f32_32x32x16_bf16 v[192:207], v[236:239], v[80:83], v[192:207]
s_waitcnt vmcnt(6)
ds_read_b64_tr_b16 v[96:97], v185 offset:40960
ds_read_b64_tr_b16 v[98:99], v185 offset:41216
ds_read_b64_tr_b16 v[100:101], v185 offset:16384
ds_read_b64_tr_b16 v[102:103], v185 offset:16640
v_mfma_f32_32x32x16_bf16 v[208:223], v[236:239], v[84:87], v[208:223]
ds_read_b128 v[224:227], v248 offset:384
ds_read_b128 v[228:231], v248 offset:17024
s_waitcnt lgkmcnt(7)
v_mfma_f32_32x32x16_bf16 v[128:143], v[240:243], v[88:91], v[128:143]
s_waitcnt lgkmcnt(2)
v_mfma_f32_32x32x16_bf16 v[144:159], v[240:243], v[92:95], v[144:159]
v_mfma_f32_32x32x16_bf16 v[192:207], v[244:247], v[88:91], v[192:207]
s_waitcnt vmcnt(4)
ds_read_b64_tr_b16 v[104:105], v185 offset:24576
ds_read_b64_tr_b16 v[106:107], v185 offset:24832
ds_read_b64_tr_b16 v[108:109], v185
ds_read_b64_tr_b16 v[110:111], v185 offset:256
v_mfma_f32_32x32x16_bf16 v[208:223], v[244:247], v[92:95], v[208:223]
ds_read_b128 v[232:235], v248 offset:416
ds_read_b128 v[236:239], v248 offset:17056
s_waitcnt lgkmcnt(7)
v_mfma_f32_32x32x16_bf16 v[128:143], v[224:227], v[96:99], v[128:143]
s_waitcnt lgkmcnt(2)
v_mfma_f32_32x32x16_bf16 v[144:159], v[224:227], v[100:103], v[144:159]
v_mfma_f32_32x32x16_bf16 v[192:207], v[228:231], v[96:99], v[192:207]
s_waitcnt vmcnt(2)
ds_read_b64_tr_b16 v[112:113], v185 offset:8192
ds_read_b64_tr_b16 v[114:115], v185 offset:8448
ds_read_b64_tr_b16 v[116:117], v160
ds_read_b64_tr_b16 v[118:119], v160 offset:256
v_mfma_f32_32x32x16_bf16 v[208:223], v[228:231], v[100:103], v[208:223]
ds_read_b128 v[240:243], v248 offset:448
ds_read_b128 v[244:247], v248 offset:17088
s_waitcnt lgkmcnt(7)
v_mfma_f32_32x32x16_bf16 v[128:143], v[232:235], v[104:107], v[128:143]
s_waitcnt lgkmcnt(2)
v_mfma_f32_32x32x16_bf16 v[144:159], v[232:235], v[108:111], v[144:159]
v_mfma_f32_32x32x16_bf16 v[192:207], v[236:239], v[104:107], v[192:207]
s_waitcnt vmcnt(0)
ds_read_b64_tr_b16 v[120:121], v160 offset:1024
ds_read_b64_tr_b16 v[122:123], v160 offset:1280
ds_read_b64_tr_b16 v[124:125], v160 offset:2048
ds_read_b64_tr_b16 v[126:127], v160 offset:2304
v_mfma_f32_32x32x16_bf16 v[208:223], v[236:239], v[108:111], v[208:223]
ds_read_b128 v[224:227], v248 offset:480
ds_read_b128 v[228:231], v248 offset:17120
s_waitcnt lgkmcnt(7)
v_mfma_f32_32x32x16_bf16 v[128:143], v[240:243], v[112:115], v[128:143]
s_waitcnt lgkmcnt(2)
v_mfma_f32_32x32x16_bf16 v[144:159], v[240:243], v[116:119], v[144:159]
v_mfma_f32_32x32x16_bf16 v[192:207], v[244:247], v[112:115], v[192:207]
v_mfma_f32_32x32x16_bf16 v[208:223], v[244:247], v[116:119], v[208:223]
s_waitcnt lgkmcnt(1)
v_mfma_f32_32x32x16_bf16 v[128:143], v[224:227], v[120:123], v[128:143]
v_mfma_f32_32x32x16_bf16 v[144:159], v[224:227], v[124:127], v[144:159]
s_waitcnt lgkmcnt(0)
v_mfma_f32_32x32x16_bf16 v[192:207], v[228:231], v[120:123], v[192:207]
v_mfma_f32_32x32x16_bf16 v[208:223], v[228:231], v[124:127], v[208:223]
s_setprio 1
ds_read2_b32 v[224:225], v253 offset0:0 offset1:2
ds_read2_b32 v[226:227], v253 offset0:4 offset1:6
ds_read2_b32 v[228:229], v253 offset0:8 offset1:10
ds_read2_b32 v[230:231], v253 offset0:12 offset1:14
ds_read2_b32 v[232:233], v253 offset0:16 offset1:18
ds_read2_b32 v[234:235], v253 offset0:20 offset1:22
ds_read2_b32 v[236:237], v253 offset0:24 offset1:26
ds_read2_b32 v[238:239], v253 offset0:28 offset1:30
ds_read2_b32 v[240:241], v253 offset0:32 offset1:34
ds_read2_b32 v[242:243], v253 offset0:36 offset1:38
v_mul_f32 v152, s37, v152
v_mul_f32 v153, s37, v153
v_mul_f32 v154, s37, v154
v_mul_f32 v155, s37, v155
v_exp_f32 v152, v152
v_exp_f32 v153, v153
v_exp_f32 v154, v154
v_exp_f32 v155, v155
v_fma_f32 v152, v152, s38, s38
v_fma_f32 v153, v153, s38, s38
v_fma_f32 v154, v154, s38, s38
v_fma_f32 v155, v155, s38, s38
v_rcp_f32 v152, v152
v_rcp_f32 v153, v153
v_rcp_f32 v154, v154
v_rcp_f32 v155, v155
v_mul_f32 v136, v136, v152
v_mul_f32 v137, v137, v153
v_mul_f32 v138, v138, v154
v_mul_f32 v139, v139, v155
v_cvt_pk_bf16_f32 v128, v136, v137
v_cvt_pk_bf16_f32 v129, v138, v139
v_mul_f32 v156, s37, v156
v_mul_f32 v157, s37, v157
v_mul_f32 v158, s37, v158
v_mul_f32 v159, s37, v159
v_exp_f32 v156, v156
v_exp_f32 v157, v157
v_exp_f32 v158, v158
v_exp_f32 v159, v159
v_fma_f32 v156, v156, s38, s38
v_fma_f32 v157, v157, s38, s38
v_fma_f32 v158, v158, s38, s38
v_fma_f32 v159, v159, s38, s38
v_rcp_f32 v156, v156
v_rcp_f32 v157, v157
v_rcp_f32 v158, v158
v_rcp_f32 v159, v159
v_mul_f32 v140, v140, v156
v_mul_f32 v141, v141, v157
v_mul_f32 v142, v142, v158
v_mul_f32 v143, v143, v159
v_cvt_pk_bf16_f32 v130, v140, v141
v_cvt_pk_bf16_f32 v131, v142, v143
v_mul_f32 v208, s37, v208
v_mul_f32 v209, s37, v209
v_mul_f32 v210, s37, v210
v_mul_f32 v211, s37, v211
v_exp_f32 v208, v208
v_exp_f32 v209, v209
v_exp_f32 v210, v210
v_exp_f32 v211, v211
v_fma_f32 v208, v208, s38, s38
v_fma_f32 v209, v209, s38, s38
v_fma_f32 v210, v210, s38, s38
v_fma_f32 v211, v211, s38, s38
v_rcp_f32 v208, v208
v_rcp_f32 v209, v209
v_rcp_f32 v210, v210
v_rcp_f32 v211, v211
v_mul_f32 v192, v192, v208
v_mul_f32 v193, v193, v209
v_mul_f32 v194, v194, v210
v_mul_f32 v195, v195, v211
v_cvt_pk_bf16_f32 v208, v192, v193
v_cvt_pk_bf16_f32 v209, v194, v195
v_mul_f32 v212, s37, v212
v_mul_f32 v213, s37, v213
v_mul_f32 v214, s37, v214
v_mul_f32 v215, s37, v215
v_exp_f32 v212, v212
v_exp_f32 v213, v213
v_exp_f32 v214, v214
v_exp_f32 v215, v215
v_fma_f32 v212, v212, s38, s38
v_fma_f32 v213, v213, s38, s38
v_fma_f32 v214, v214, s38, s38
v_fma_f32 v215, v215, s38, s38
v_rcp_f32 v212, v212
v_rcp_f32 v213, v213
v_rcp_f32 v214, v214
v_rcp_f32 v215, v215
v_mul_f32 v196, v196, v212
v_mul_f32 v197, v197, v213
v_mul_f32 v198, v198, v214
v_mul_f32 v199, v199, v215
v_cvt_pk_bf16_f32 v210, v196, v197
v_cvt_pk_bf16_f32 v211, v198, v199
v_mul_f32 v216, s37, v216
v_mul_f32 v217, s37, v217
v_mul_f32 v218, s37, v218
v_mul_f32 v219, s37, v219
v_exp_f32 v216, v216
v_exp_f32 v217, v217
v_exp_f32 v218, v218
v_exp_f32 v219, v219
v_fma_f32 v216, v216, s38, s38
v_fma_f32 v217, v217, s38, s38
v_fma_f32 v218, v218, s38, s38
v_fma_f32 v219, v219, s38, s38
v_rcp_f32 v216, v216
v_rcp_f32 v217, v217
v_rcp_f32 v218, v218
v_rcp_f32 v219, v219
v_mul_f32 v200, v200, v216
v_mul_f32 v201, v201, v217
v_mul_f32 v202, v202, v218
v_mul_f32 v203, v203, v219
v_cvt_pk_bf16_f32 v244, v200, v201
v_cvt_pk_bf16_f32 v245, v202, v203
v_mul_f32 v220, s37, v220
v_mul_f32 v221, s37, v221
v_mul_f32 v222, s37, v222
v_mul_f32 v223, s37, v223
v_exp_f32 v220, v220
v_exp_f32 v221, v221
v_exp_f32 v222, v222
v_exp_f32 v223, v223
v_fma_f32 v220, v220, s38, s38
v_fma_f32 v221, v221, s38, s38
v_fma_f32 v222, v222, s38, s38
v_fma_f32 v223, v223, s38, s38
v_rcp_f32 v220, v220
v_rcp_f32 v221, v221
v_rcp_f32 v222, v222
v_rcp_f32 v223, v223
v_mul_f32 v204, v204, v220
v_mul_f32 v205, v205, v221
v_mul_f32 v206, v206, v222
v_mul_f32 v207, v207, v223
v_cvt_pk_bf16_f32 v246, v204, v205
v_cvt_pk_bf16_f32 v247, v206, v207
s_barrier
ds_write_b128 v249, v[128:131]
ds_write_b128 v249, v[208:211] offset:32
ds_write_b128 v249, v[244:247] offset:64
ds_read_b128 v[192:195], v250
ds_read_b128 v[212:215], v250 offset:1536
ds_read_b128 v[196:199], v250 offset:16
ds_read_b128 v[216:219], v250 offset:1552
ds_read_b128 v[200:203], v250 offset:32
ds_read_b128 v[220:223], v250 offset:1568
ds_write_b128 v249, v[244:247]
s_waitcnt lgkmcnt(1)
s_setprio 3
v_mfma_f32_4x4x4_16b_bf16 v[204:207], v[224:225], v[192:193], 0
v_mfma_f32_4x4x4_16b_bf16 v[208:211], v[224:225], v[194:195], 0
v_mfma_f32_4x4x4_16b_bf16 v[244:247], v[234:235], v[212:213], 0
v_mfma_f32_4x4x4_16b_bf16 v[204:207], v[226:227], v[194:195], v[204:207]
v_mfma_f32_4x4x4_16b_bf16 v[208:211], v[226:227], v[196:197], v[208:211]
v_mfma_f32_4x4x4_16b_bf16 v[224:227], v[234:235], v[214:215], 0
v_mfma_f32_4x4x4_16b_bf16 v[244:247], v[236:237], v[214:215], v[244:247]
v_mfma_f32_4x4x4_16b_bf16 v[204:207], v[228:229], v[196:197], v[204:207]
v_mfma_f32_4x4x4_16b_bf16 v[224:227], v[236:237], v[216:217], v[224:227]
v_mfma_f32_4x4x4_16b_bf16 v[208:211], v[228:229], v[198:199], v[208:211]
v_mfma_f32_4x4x4_16b_bf16 v[244:247], v[238:239], v[216:217], v[244:247]
v_mfma_f32_4x4x4_16b_bf16 v[204:207], v[230:231], v[198:199], v[204:207]
v_mfma_f32_4x4x4_16b_bf16 v[224:227], v[238:239], v[218:219], v[224:227]
v_mfma_f32_4x4x4_16b_bf16 v[208:211], v[230:231], v[200:201], v[208:211]
v_mfma_f32_4x4x4_16b_bf16 v[244:247], v[240:241], v[218:219], v[244:247]
v_mfma_f32_4x4x4_16b_bf16 v[224:227], v[240:241], v[220:221], v[224:227]
v_mfma_f32_4x4x4_16b_bf16 v[204:207], v[232:233], v[200:201], v[204:207]
v_mfma_f32_4x4x4_16b_bf16 v[208:211], v[232:233], v[202:203], v[208:211]
v_mfma_f32_4x4x4_16b_bf16 v[244:247], v[242:243], v[220:221], v[244:247]
v_mfma_f32_4x4x4_16b_bf16 v[224:227], v[242:243], v[222:223], v[224:227]
s_setprio 1
s_nop 0
v_exp_f32 v192, v204
v_exp_f32 v193, v205
v_exp_f32 v194, v206
v_exp_f32 v195, v207
v_fma_f32 v192, v192, s37, s37
v_fma_f32 v193, v193, s37, s37
v_fma_f32 v194, v194, s37, s37
v_fma_f32 v195, v195, s37, s37
v_rcp_f32 v192, v192
v_rcp_f32 v193, v193
v_rcp_f32 v194, v194
v_rcp_f32 v195, v195
v_mul_f32 v204, v204, v192
v_mul_f32 v205, v205, v193
v_mul_f32 v206, v206, v194
v_mul_f32 v207, v207, v195
v_cvt_pk_bf16_f32 v204, v204, v205
v_cvt_pk_bf16_f32 v205, v206, v207
v_exp_f32 v196, v208
v_exp_f32 v197, v209
s_add_u32 m0, s41, 16384
s_nop 0
buffer_load_dwordx4 v191, s[24:27], 0 offen lds
v_exp_f32 v198, v210
s_add_u32 m0, s41, 24576
s_mov_b32 s44, 16384
buffer_load_dwordx4 v191, s[24:27], s44 offen lds
v_exp_f32 v199, v211
s_add_u32 m0, s41, 32768
s_mov_b32 s42, 32768
buffer_load_dwordx4 v191, s[24:27], s42 offen lds
v_fma_f32 v196, v196, s37, s37
s_add_u32 m0, s41, 40960
s_mov_b32 s43, 49152
buffer_load_dwordx4 v191, s[24:27], s43 offen lds
v_fma_f32 v197, v197, s37, s37
v_fma_f32 v198, v198, s37, s37
v_fma_f32 v199, v199, s37, s37
v_rcp_f32 v196, v196
v_rcp_f32 v197, v197
v_rcp_f32 v198, v198
v_rcp_f32 v199, v199
v_mul_f32 v208, v208, v196
v_mul_f32 v209, v209, v197
v_mul_f32 v210, v210, v198
v_mul_f32 v211, v211, v199
v_cvt_pk_bf16_f32 v206, v208, v209
v_cvt_pk_bf16_f32 v207, v210, v211
v_exp_f32 v192, v244
v_exp_f32 v193, v245
v_exp_f32 v194, v246
v_exp_f32 v195, v247
v_fma_f32 v192, v192, s37, s37
v_fma_f32 v193, v193, s37, s37
v_fma_f32 v194, v194, s37, s37
v_fma_f32 v195, v195, s37, s37
v_rcp_f32 v192, v192
v_rcp_f32 v193, v193
v_rcp_f32 v194, v194
v_rcp_f32 v195, v195
v_mul_f32 v244, v244, v192
v_mul_f32 v245, v245, v193
v_mul_f32 v246, v246, v194
v_mul_f32 v247, v247, v195
v_cvt_pk_bf16_f32 v244, v244, v245
v_cvt_pk_bf16_f32 v245, v246, v247
v_exp_f32 v196, v224
v_exp_f32 v197, v225
v_exp_f32 v198, v226
v_exp_f32 v199, v227
v_fma_f32 v196, v196, s37, s37
v_fma_f32 v197, v197, s37, s37
v_fma_f32 v198, v198, s37, s37
v_fma_f32 v199, v199, s37, s37
v_rcp_f32 v196, v196
v_rcp_f32 v197, v197
v_rcp_f32 v198, v198
v_rcp_f32 v199, v199
v_mul_f32 v224, v224, v196
v_mul_f32 v225, v225, v197
v_mul_f32 v226, v226, v198
v_mul_f32 v227, v227, v199
v_cvt_pk_bf16_f32 v246, v224, v225
v_cvt_pk_bf16_f32 v247, v226, v227
s_barrier
s_setprio 1
ds_write_b128 v251, v[204:207]
ds_write_b128 v251, v[244:247] offset:8192
ds_read_b128 v[240:243], v248 offset:33280
ds_read_b128 v[244:247], v248 offset:33312
ds_read_b128 v[232:235], v248 offset:33344
ds_read_b128 v[236:239], v248 offset:33376
s_waitcnt lgkmcnt(3)
v_mfma_f32_32x32x16_bf16 v[192:207], v[240:243], v[0:3], 0
v_mfma_f32_32x32x16_bf16 v[208:223], v[240:243], v[4:7], 0
ds_read_b128 v[240:243], v248 offset:33408
s_waitcnt lgkmcnt(3)
v_mfma_f32_32x32x16_bf16 v[192:207], v[244:247], v[8:11], v[192:207]
v_mfma_f32_32x32x16_bf16 v[208:223], v[244:247], v[12:15], v[208:223]
ds_read_b128 v[244:247], v248 offset:33440
s_waitcnt vmcnt(3)
ds_read_b64_tr_b16 v[128:129], v189 offset:16384
ds_read_b64_tr_b16 v[130:131], v189 offset:16640
s_waitcnt lgkmcnt(5)
v_mfma_f32_32x32x16_bf16 v[192:207], v[232:235], v[16:19], v[192:207]
v_mfma_f32_32x32x16_bf16 v[208:223], v[232:235], v[20:23], v[208:223]
ds_read_b128 v[232:235], v248 offset:33472
s_waitcnt vmcnt(2)
ds_read_b64_tr_b16 v[132:133], v189 offset:24576
ds_read_b64_tr_b16 v[134:135], v189 offset:24832
s_waitcnt lgkmcnt(7)
v_mfma_f32_32x32x16_bf16 v[192:207], v[236:239], v[24:27], v[192:207]
v_mfma_f32_32x32x16_bf16 v[208:223], v[236:239], v[28:31], v[208:223]
ds_read_b128 v[236:239], v248 offset:33504
s_waitcnt vmcnt(1)
ds_read_b64_tr_b16 v[136:137], v189 offset:32768
ds_read_b64_tr_b16 v[138:139], v189 offset:33024
s_waitcnt lgkmcnt(9)
v_mfma_f32_32x32x16_bf16 v[192:207], v[240:243], v[32:35], v[192:207]
v_mfma_f32_32x32x16_bf16 v[208:223], v[240:243], v[36:39], v[208:223]
ds_read_b128 v[240:243], v248 offset:33536
s_waitcnt vmcnt(0)
ds_read_b64_tr_b16 v[140:141], v189 offset:40960
ds_read_b64_tr_b16 v[142:143], v189 offset:41216
s_waitcnt lgkmcnt(11)
v_mfma_f32_32x32x16_bf16 v[192:207], v[244:247], v[40:43], v[192:207]
v_mfma_f32_32x32x16_bf16 v[208:223], v[244:247], v[44:47], v[208:223]
ds_read_b128 v[244:247], v248 offset:33568
s_waitcnt lgkmcnt(9)
v_mfma_f32_32x32x16_bf16 v[192:207], v[232:235], v[48:51], v[192:207]
v_mfma_f32_32x32x16_bf16 v[208:223], v[232:235], v[52:55], v[208:223]
ds_read_b128 v[232:235], v248 offset:33600
s_waitcnt lgkmcnt(7)
v_mfma_f32_32x32x16_bf16 v[192:207], v[236:239], v[56:59], v[192:207]
v_mfma_f32_32x32x16_bf16 v[208:223], v[236:239], v[60:63], v[208:223]
ds_read_b128 v[236:239], v248 offset:33632
s_waitcnt lgkmcnt(5)
v_mfma_f32_32x32x16_bf16 v[192:207], v[240:243], v[64:67], v[192:207]
v_mfma_f32_32x32x16_bf16 v[208:223], v[240:243], v[68:71], v[208:223]
ds_read_b128 v[240:243], v248 offset:33664
s_waitcnt lgkmcnt(3)
v_mfma_f32_32x32x16_bf16 v[192:207], v[244:247], v[72:75], v[192:207]
v_mfma_f32_32x32x16_bf16 v[208:223], v[244:247], v[76:79], v[208:223]
ds_read_b128 v[244:247], v248 offset:33696
s_waitcnt lgkmcnt(3)
v_mfma_f32_32x32x16_bf16 v[192:207], v[232:235], v[80:83], v[192:207]
v_mfma_f32_32x32x16_bf16 v[208:223], v[232:235], v[84:87], v[208:223]
ds_read_b128 v[232:235], v248 offset:33728
s_waitcnt lgkmcnt(3)
v_mfma_f32_32x32x16_bf16 v[192:207], v[236:239], v[88:91], v[192:207]
v_mfma_f32_32x32x16_bf16 v[208:223], v[236:239], v[92:95], v[208:223]
ds_read_b128 v[236:239], v248 offset:33760
s_waitcnt lgkmcnt(3)
v_mfma_f32_32x32x16_bf16 v[192:207], v[240:243], v[96:99], v[192:207]
v_mfma_f32_32x32x16_bf16 v[208:223], v[240:243], v[100:103], v[208:223]
ds_read2_b32 v[224:225], v253 offset0:0 offset1:2
ds_read2_b32 v[226:227], v253 offset0:4 offset1:6
ds_read2_b32 v[228:229], v253 offset0:8 offset1:10
ds_read2_b32 v[230:231], v253 offset0:12 offset1:14
s_waitcnt lgkmcnt(6)
v_mfma_f32_32x32x16_bf16 v[192:207], v[244:247], v[104:107], v[192:207]
v_mfma_f32_32x32x16_bf16 v[208:223], v[244:247], v[108:111], v[208:223]
ds_read2_b32 v[240:241], v253 offset0:32 offset1:34
ds_read2_b32 v[242:243], v253 offset0:36 offset1:38
s_mov_b32 m0, s46
s_mov_b32 s44, 65536
buffer_load_dwordx4 v191, s[24:27], s44 offen lds
s_add_u32 m0, s46, 1024
s_mov_b32 s42, 81920
buffer_load_dwordx4 v191, s[24:27], s42 offen lds
s_add_u32 m0, s46, 2048
s_mov_b32 s43, 98304
buffer_load_dwordx4 v191, s[24:27], s43 offen lds
s_waitcnt lgkmcnt(7)
v_mfma_f32_32x32x16_bf16 v[192:207], v[232:235], v[112:115], v[192:207]
v_mfma_f32_32x32x16_bf16 v[208:223], v[232:235], v[116:119], v[208:223]
ds_read2_b32 v[232:233], v253 offset0:16 offset1:18
ds_read2_b32 v[234:235], v253 offset0:20 offset1:22
s_add_u32 m0, s46, 3072
s_mov_b32 s44, 114688
buffer_load_dwordx4 v191, s[24:27], s44 offen lds
s_add_u32 m0, s41, 16384
s_mov_b32 s42, 8192
buffer_load_dwordx4 v191, s[24:27], s42 offen lds
s_add_u32 m0, s41, 24576
s_mov_b32 s43, 24576
buffer_load_dwordx4 v191, s[24:27], s43 offen lds
s_waitcnt lgkmcnt(8)
v_mfma_f32_32x32x16_bf16 v[192:207], v[236:239], v[120:123], v[192:207]
v_mfma_f32_32x32x16_bf16 v[208:223], v[236:239], v[124:127], v[208:223]
ds_read2_b32 v[236:237], v253 offset0:24 offset1:26
ds_read2_b32 v[238:239], v253 offset0:28 offset1:30
s_add_u32 m0, s41, 32768
s_mov_b32 s44, 40960
buffer_load_dwordx4 v191, s[24:27], s44 offen lds
s_add_u32 m0, s41, 40960
s_mov_b32 s42, 57344
buffer_load_dwordx4 v191, s[24:27], s42 offen lds
s_barrier
s_setprio 0
s_nop 1
v_mul_f32 v208, s37, v208
v_mul_f32 v209, s37, v209
v_mul_f32 v210, s37, v210
v_mul_f32 v211, s37, v211
v_exp_f32 v208, v208
v_exp_f32 v209, v209
v_exp_f32 v210, v210
v_exp_f32 v211, v211
v_fma_f32 v208, v208, s38, s38
s_waitcnt vmcnt(7)
ds_read_b64_tr_b16 v[144:145], v190
ds_read_b64_tr_b16 v[146:147], v190 offset:256
v_fma_f32 v209, v209, s38, s38
v_fma_f32 v210, v210, s38, s38
v_fma_f32 v211, v211, s38, s38
v_rcp_f32 v208, v208
v_rcp_f32 v209, v209
v_rcp_f32 v210, v210
v_rcp_f32 v211, v211
v_mul_f32 v192, v192, v208
s_waitcnt vmcnt(6)
ds_read_b64_tr_b16 v[148:149], v190 offset:1024
ds_read_b64_tr_b16 v[150:151], v190 offset:1280
v_mul_f32 v193, v193, v209
v_mul_f32 v194, v194, v210
v_mul_f32 v195, v195, v211
v_cvt_pk_bf16_f32 v208, v192, v193
v_cvt_pk_bf16_f32 v209, v194, v195
v_mul_f32 v212, s37, v212
v_mul_f32 v213, s37, v213
v_mul_f32 v214, s37, v214
s_waitcnt lgkmcnt(2)
s_mov_b32 m0, s46
s_mov_b32 s43, 73728
buffer_load_dwordx4 v191, s[24:27], s43 offen lds
s_waitcnt vmcnt(6)
ds_read_b64_tr_b16 v[152:153], v190 offset:2048
ds_read_b64_tr_b16 v[154:155], v190 offset:2304
v_mul_f32 v215, s37, v215
v_exp_f32 v212, v212
v_exp_f32 v213, v213
v_exp_f32 v214, v214
v_exp_f32 v215, v215
v_fma_f32 v212, v212, s38, s38
v_fma_f32 v213, v213, s38, s38
v_fma_f32 v214, v214, s38, s38
s_waitcnt lgkmcnt(2)
s_add_u32 m0, s46, 1024
s_mov_b32 s44, 90112
buffer_load_dwordx4 v191, s[24:27], s44 offen lds
s_waitcnt vmcnt(6)
ds_read_b64_tr_b16 v[156:157], v190 offset:3072
ds_read_b64_tr_b16 v[158:159], v190 offset:3328
v_fma_f32 v215, v215, s38, s38
v_rcp_f32 v212, v212
v_rcp_f32 v213, v213
v_rcp_f32 v214, v214
v_rcp_f32 v215, v215
v_mul_f32 v196, v196, v212
v_mul_f32 v197, v197, v213
v_mul_f32 v198, v198, v214
s_waitcnt vmcnt(5)
ds_read_b64_tr_b16 v[160:161], v189 offset:16384
ds_read_b64_tr_b16 v[162:163], v189 offset:16640
v_mul_f32 v199, v199, v215
v_cvt_pk_bf16_f32 v210, v196, v197
v_cvt_pk_bf16_f32 v211, v198, v199
ds_write_b128 v249, v[208:211] offset:32
ds_read_b128 v[192:195], v250
ds_read_b128 v[212:215], v250 offset:1536
v_mul_f32 v216, s37, v216
v_mul_f32 v217, s37, v217
v_mul_f32 v218, s37, v218
v_mul_f32 v219, s37, v219
s_waitcnt vmcnt(4)
ds_read_b64_tr_b16 v[164:165], v189 offset:24576
ds_read_b64_tr_b16 v[166:167], v189 offset:24832
v_exp_f32 v216, v216
v_exp_f32 v217, v217
v_exp_f32 v218, v218
v_exp_f32 v219, v219
v_fma_f32 v216, v216, s38, s38
v_fma_f32 v217, v217, s38, s38
v_fma_f32 v218, v218, s38, s38
v_fma_f32 v219, v219, s38, s38
v_rcp_f32 v216, v216
v_rcp_f32 v217, v217
v_rcp_f32 v218, v218
v_rcp_f32 v219, v219
v_mul_f32 v200, v200, v216
v_mul_f32 v201, v201, v217
v_mul_f32 v202, v202, v218
v_mul_f32 v203, v203, v219
v_cvt_pk_bf16_f32 v244, v200, v201
v_cvt_pk_bf16_f32 v245, v202, v203
v_mul_f32 v220, s37, v220
v_mul_f32 v221, s37, v221
v_mul_f32 v222, s37, v222
v_mul_f32 v223, s37, v223
v_exp_f32 v220, v220
v_exp_f32 v221, v221
v_exp_f32 v222, v222
v_exp_f32 v223, v223
v_fma_f32 v220, v220, s38, s38
v_fma_f32 v221, v221, s38, s38
v_fma_f32 v222, v222, s38, s38
v_fma_f32 v223, v223, s38, s38
v_rcp_f32 v220, v220
v_rcp_f32 v221, v221
v_rcp_f32 v222, v222
v_rcp_f32 v223, v223
v_mul_f32 v204, v204, v220
v_mul_f32 v205, v205, v221
v_mul_f32 v206, v206, v222
v_mul_f32 v207, v207, v223
v_cvt_pk_bf16_f32 v246, v204, v205
v_cvt_pk_bf16_f32 v247, v206, v207
ds_write_b128 v249, v[244:247] offset:64
ds_read_b128 v[196:199], v250 offset:16
ds_read_b128 v[216:219], v250 offset:1552
ds_read_b128 v[200:203], v250 offset:32
ds_read_b128 v[220:223], v250 offset:1568
ds_write_b128 v249, v[244:247]
s_waitcnt lgkmcnt(0)
s_setprio 3
v_mfma_f32_4x4x4_16b_bf16 v[204:207], v[224:225], v[192:193], 0
v_mfma_f32_4x4x4_16b_bf16 v[208:211], v[224:225], v[194:195], 0
v_mfma_f32_4x4x4_16b_bf16 v[244:247], v[234:235], v[212:213], 0
v_mfma_f32_4x4x4_16b_bf16 v[204:207], v[226:227], v[194:195], v[204:207]
v_mfma_f32_4x4x4_16b_bf16 v[208:211], v[226:227], v[196:197], v[208:211]
v_mfma_f32_4x4x4_16b_bf16 v[224:227], v[234:235], v[214:215], 0
v_mfma_f32_4x4x4_16b_bf16 v[244:247], v[236:237], v[214:215], v[244:247]
v_mfma_f32_4x4x4_16b_bf16 v[204:207], v[228:229], v[196:197], v[204:207]
v_mfma_f32_4x4x4_16b_bf16 v[224:227], v[236:237], v[216:217], v[224:227]
v_mfma_f32_4x4x4_16b_bf16 v[208:211], v[228:229], v[198:199], v[208:211]
v_mfma_f32_4x4x4_16b_bf16 v[244:247], v[238:239], v[216:217], v[244:247]
v_mfma_f32_4x4x4_16b_bf16 v[204:207], v[230:231], v[198:199], v[204:207]
v_mfma_f32_4x4x4_16b_bf16 v[224:227], v[238:239], v[218:219], v[224:227]
v_mfma_f32_4x4x4_16b_bf16 v[208:211], v[230:231], v[200:201], v[208:211]
v_mfma_f32_4x4x4_16b_bf16 v[244:247], v[240:241], v[218:219], v[244:247]
v_mfma_f32_4x4x4_16b_bf16 v[224:227], v[240:241], v[220:221], v[224:227]
v_mfma_f32_4x4x4_16b_bf16 v[204:207], v[232:233], v[200:201], v[204:207]
v_mfma_f32_4x4x4_16b_bf16 v[208:211], v[232:233], v[202:203], v[208:211]
v_mfma_f32_4x4x4_16b_bf16 v[244:247], v[242:243], v[220:221], v[244:247]
v_mfma_f32_4x4x4_16b_bf16 v[224:227], v[242:243], v[222:223], v[224:227]
s_setprio 0
s_nop 0
v_exp_f32 v192, v204
v_exp_f32 v193, v205
v_exp_f32 v194, v206
v_exp_f32 v195, v207
v_fma_f32 v192, v192, s37, s37
v_fma_f32 v193, v193, s37, s37
v_fma_f32 v194, v194, s37, s37
v_fma_f32 v195, v195, s37, s37
v_rcp_f32 v192, v192
v_rcp_f32 v193, v193
v_rcp_f32 v194, v194
v_rcp_f32 v195, v195
v_mul_f32 v204, v204, v192
v_mul_f32 v205, v205, v193
v_mul_f32 v206, v206, v194
v_mul_f32 v207, v207, v195
v_cvt_pk_bf16_f32 v204, v204, v205
v_cvt_pk_bf16_f32 v205, v206, v207
v_exp_f32 v196, v208
v_exp_f32 v197, v209
v_exp_f32 v198, v210
v_exp_f32 v199, v211
v_fma_f32 v196, v196, s37, s37
v_fma_f32 v197, v197, s37, s37
v_fma_f32 v198, v198, s37, s37
v_fma_f32 v199, v199, s37, s37
v_rcp_f32 v196, v196
v_rcp_f32 v197, v197
v_rcp_f32 v198, v198
v_rcp_f32 v199, v199
v_mul_f32 v208, v208, v196
v_mul_f32 v209, v209, v197
v_mul_f32 v210, v210, v198
v_mul_f32 v211, v211, v199
v_cvt_pk_bf16_f32 v206, v208, v209
v_cvt_pk_bf16_f32 v207, v210, v211
ds_write_b128 v251, v[204:207] offset:16384
v_exp_f32 v192, v244
v_exp_f32 v193, v245
v_exp_f32 v194, v246
ds_read_b64_tr_b16 v[200:201], v252
ds_read_b64_tr_b16 v[202:203], v252 offset:256
v_exp_f32 v195, v247
v_fma_f32 v192, v192, s37, s37
v_fma_f32 v193, v193, s37, s37
v_fma_f32 v194, v194, s37, s37
v_fma_f32 v195, v195, s37, s37
ds_read_b64_tr_b16 v[212:213], v252 offset:1024
ds_read_b64_tr_b16 v[214:215], v252 offset:1280
v_rcp_f32 v192, v192
v_rcp_f32 v193, v193
v_rcp_f32 v194, v194
v_rcp_f32 v195, v195
v_mul_f32 v244, v244, v192
ds_read_b64_tr_b16 v[216:217], v252 offset:2048
ds_read_b64_tr_b16 v[218:219], v252 offset:2304
v_mul_f32 v245, v245, v193
v_mul_f32 v246, v246, v194
v_mul_f32 v247, v247, v195
v_cvt_pk_bf16_f32 v244, v244, v245
v_cvt_pk_bf16_f32 v245, v246, v247
ds_read_b64_tr_b16 v[220:221], v252 offset:3072
ds_read_b64_tr_b16 v[222:223], v252 offset:3328
v_exp_f32 v196, v224
v_exp_f32 v197, v225
v_exp_f32 v198, v226
v_exp_f32 v199, v227
v_fma_f32 v196, v196, s37, s37
ds_read_b64_tr_b16 v[204:205], v252 offset:4096
ds_read_b64_tr_b16 v[206:207], v252 offset:4352
v_fma_f32 v197, v197, s37, s37
v_fma_f32 v198, v198, s37, s37
v_fma_f32 v199, v199, s37, s37
v_rcp_f32 v196, v196
v_rcp_f32 v197, v197
ds_read_b64_tr_b16 v[208:209], v252 offset:5120
ds_read_b64_tr_b16 v[210:211], v252 offset:5376
v_rcp_f32 v198, v198
v_rcp_f32 v199, v199
v_mul_f32 v224, v224, v196
v_mul_f32 v225, v225, v197
v_mul_f32 v226, v226, v198
v_mul_f32 v227, v227, v199
v_cvt_pk_bf16_f32 v246, v224, v225
v_cvt_pk_bf16_f32 v247, v226, v227
ds_write_b128 v251, v[244:247] offset:24576
s_setprio 1
s_waitcnt lgkmcnt(11)
v_mfma_f32_32x32x16_bf16 v[224:239], v[128:131], v[200:203], 0
ds_read_b64_tr_b16 v[192:193], v252 offset:6144
ds_read_b64_tr_b16 v[194:195], v252 offset:6400
s_waitcnt lgkmcnt(11)
v_mfma_f32_32x32x16_bf16 v[224:239], v[132:135], v[212:215], v[224:239]
ds_read_b64_tr_b16 v[196:197], v252 offset:7168
ds_read_b64_tr_b16 v[198:199], v252 offset:7424
s_waitcnt lgkmcnt(11)
v_mfma_f32_32x32x16_bf16 v[224:239], v[136:139], v[216:219], v[224:239]
ds_read_b64_tr_b16 v[200:201], v252 offset:8192
ds_read_b64_tr_b16 v[202:203], v252 offset:8448
s_waitcnt lgkmcnt(11)
v_mfma_f32_32x32x16_bf16 v[224:239], v[140:143], v[220:223], v[224:239]
ds_read_b64_tr_b16 v[212:213], v252 offset:9216
ds_read_b64_tr_b16 v[214:215], v252 offset:9472
s_waitcnt lgkmcnt(11)
v_mfma_f32_32x32x16_bf16 v[224:239], v[144:147], v[204:207], v[224:239]
ds_read_b64_tr_b16 v[216:217], v252 offset:10240
ds_read_b64_tr_b16 v[218:219], v252 offset:10496
s_waitcnt lgkmcnt(11)
v_mfma_f32_32x32x16_bf16 v[224:239], v[148:151], v[208:211], v[224:239]
ds_read_b64_tr_b16 v[220:221], v252 offset:11264
ds_read_b64_tr_b16 v[222:223], v252 offset:11520
s_waitcnt lgkmcnt(10)
v_mfma_f32_32x32x16_bf16 v[224:239], v[152:155], v[192:195], v[224:239]
ds_read_b64_tr_b16 v[204:205], v252 offset:12288
ds_read_b64_tr_b16 v[206:207], v252 offset:12544
s_waitcnt vmcnt(3)
ds_read_b64_tr_b16 v[168:169], v189 offset:32768
ds_read_b64_tr_b16 v[170:171], v189 offset:33024
s_waitcnt lgkmcnt(12)
v_mfma_f32_32x32x16_bf16 v[224:239], v[156:159], v[196:199], v[224:239]
ds_read_b64_tr_b16 v[208:209], v252 offset:13312
ds_read_b64_tr_b16 v[210:211], v252 offset:13568
s_waitcnt vmcnt(2)
ds_read_b64_tr_b16 v[172:173], v189 offset:40960
ds_read_b64_tr_b16 v[174:175], v189 offset:41216
s_waitcnt lgkmcnt(14)
v_mfma_f32_32x32x16_bf16 v[224:239], v[160:163], v[200:203], v[224:239]
ds_read_b64_tr_b16 v[192:193], v252 offset:14336
ds_read_b64_tr_b16 v[194:195], v252 offset:14592
s_waitcnt vmcnt(1)
ds_read_b64_tr_b16 v[176:177], v190
ds_read_b64_tr_b16 v[178:179], v190 offset:256
s_waitcnt lgkmcnt(15)
v_mfma_f32_32x32x16_bf16 v[224:239], v[164:167], v[212:215], v[224:239]
ds_read_b64_tr_b16 v[196:197], v252 offset:15360
ds_read_b64_tr_b16 v[198:199], v252 offset:15616
s_waitcnt vmcnt(0)
ds_read_b64_tr_b16 v[180:181], v190 offset:1024
ds_read_b64_tr_b16 v[182:183], v190 offset:1280
s_waitcnt lgkmcnt(12)
v_mfma_f32_32x32x16_bf16 v[224:239], v[168:171], v[216:219], v[224:239]
s_barrier
ds_read_b64_tr_b16 v[184:185], v189 offset:36864
ds_read_b64_tr_b16 v[186:187], v189 offset:37120
s_waitcnt lgkmcnt(10)
v_mfma_f32_32x32x16_bf16 v[224:239], v[172:175], v[220:223], v[224:239]
ds_read_b64_tr_b16 v[190:191], v189 offset:45312
ds_read_b64_tr_b16 v[188:189], v189 offset:45056
s_waitcnt lgkmcnt(8)
v_mfma_f32_32x32x16_bf16 v[224:239], v[176:179], v[204:207], v[224:239]
ds_read_b128 v[240:243], v248 offset:49920
s_waitcnt lgkmcnt(5)
v_mfma_f32_32x32x16_bf16 v[224:239], v[180:183], v[208:211], v[224:239]
ds_read_b128 v[244:247], v248 offset:49952
s_waitcnt lgkmcnt(4)
v_mfma_f32_32x32x16_bf16 v[224:239], v[184:187], v[192:195], v[224:239]
s_waitcnt lgkmcnt(2)
v_mfma_f32_32x32x16_bf16 v[224:239], v[188:191], v[196:199], v[224:239]
s_waitcnt lgkmcnt(1)
v_mfma_f32_32x32x16_bf16 v[192:207], v[240:243], v[0:3], 0
v_mfma_f32_32x32x16_bf16 v[208:223], v[240:243], v[4:7], 0
ds_read_b128 v[240:243], v248 offset:49984
s_waitcnt lgkmcnt(1)
v_mfma_f32_32x32x16_bf16 v[192:207], v[244:247], v[8:11], v[192:207]
v_mfma_f32_32x32x16_bf16 v[208:223], v[244:247], v[12:15], v[208:223]
ds_read_b128 v[244:247], v248 offset:50016
s_nop 3
v_cvt_pk_bf16_f32 v224, v224, v225
v_cvt_pk_bf16_f32 v225, v226, v227
v_cvt_pk_bf16_f32 v226, v228, v229
v_cvt_pk_bf16_f32 v227, v230, v231
s_waitcnt lgkmcnt(1)
v_mfma_f32_32x32x16_bf16 v[192:207], v[240:243], v[16:19], v[192:207]
v_mfma_f32_32x32x16_bf16 v[208:223], v[240:243], v[20:23], v[208:223]
ds_read_b128 v[240:243], v248 offset:50048
v_cvt_pk_bf16_f32 v228, v232, v233
v_cvt_pk_bf16_f32 v229, v234, v235
v_cvt_pk_bf16_f32 v230, v236, v237
v_cvt_pk_bf16_f32 v231, v238, v239
v_permlane16_swap_b32 v224, v228
v_permlane16_swap_b32 v225, v229
v_permlane16_swap_b32 v226, v230
v_permlane16_swap_b32 v227, v231
buffer_store_dwordx4 v[224:227], v254, s[32:35], 0 offen sc0 sc1 nt
s_mov_b32 s42, 8192
buffer_store_dwordx4 v[228:231], v254, s[32:35], s42 offen sc0 sc1 nt
ds_read_b128 v[232:235], v248 offset:50080
ds_read_b128 v[236:239], v248 offset:50112
s_waitcnt lgkmcnt(3)
v_mfma_f32_32x32x16_bf16 v[192:207], v[244:247], v[24:27], v[192:207]
v_mfma_f32_32x32x16_bf16 v[208:223], v[244:247], v[28:31], v[208:223]
ds_read_b128 v[244:247], v248 offset:50144
s_waitcnt lgkmcnt(3)
v_mfma_f32_32x32x16_bf16 v[192:207], v[240:243], v[32:35], v[192:207]
v_mfma_f32_32x32x16_bf16 v[208:223], v[240:243], v[36:39], v[208:223]
ds_read_b128 v[240:243], v248 offset:50176
s_waitcnt lgkmcnt(3)
v_mfma_f32_32x32x16_bf16 v[192:207], v[232:235], v[40:43], v[192:207]
v_mfma_f32_32x32x16_bf16 v[208:223], v[232:235], v[44:47], v[208:223]
ds_read_b128 v[232:235], v248 offset:50208
s_waitcnt lgkmcnt(3)
v_mfma_f32_32x32x16_bf16 v[192:207], v[236:239], v[48:51], v[192:207]
v_mfma_f32_32x32x16_bf16 v[208:223], v[236:239], v[52:55], v[208:223]
ds_read_b128 v[236:239], v248 offset:50240
s_waitcnt lgkmcnt(3)
v_mfma_f32_32x32x16_bf16 v[192:207], v[244:247], v[56:59], v[192:207]
v_mfma_f32_32x32x16_bf16 v[208:223], v[244:247], v[60:63], v[208:223]
ds_read_b128 v[244:247], v248 offset:50272
s_waitcnt lgkmcnt(3)
v_mfma_f32_32x32x16_bf16 v[192:207], v[240:243], v[64:67], v[192:207]
v_mfma_f32_32x32x16_bf16 v[208:223], v[240:243], v[68:71], v[208:223]
ds_read_b128 v[240:243], v248 offset:50304
s_waitcnt lgkmcnt(3)
v_mfma_f32_32x32x16_bf16 v[192:207], v[232:235], v[72:75], v[192:207]
v_mfma_f32_32x32x16_bf16 v[208:223], v[232:235], v[76:79], v[208:223]
ds_read_b128 v[232:235], v248 offset:50336
s_waitcnt lgkmcnt(3)
v_mfma_f32_32x32x16_bf16 v[192:207], v[236:239], v[80:83], v[192:207]
v_mfma_f32_32x32x16_bf16 v[208:223], v[236:239], v[84:87], v[208:223]
ds_read_b128 v[236:239], v248 offset:50368
s_waitcnt lgkmcnt(3)
v_mfma_f32_32x32x16_bf16 v[192:207], v[244:247], v[88:91], v[192:207]
v_mfma_f32_32x32x16_bf16 v[208:223], v[244:247], v[92:95], v[208:223]
ds_read_b128 v[244:247], v248 offset:50400
s_waitcnt lgkmcnt(3)
v_mfma_f32_32x32x16_bf16 v[192:207], v[240:243], v[96:99], v[192:207]
v_mfma_f32_32x32x16_bf16 v[208:223], v[240:243], v[100:103], v[208:223]
ds_read2_b32 v[224:225], v253 offset0:0 offset1:2
ds_read2_b32 v[226:227], v253 offset0:4 offset1:6
ds_read2_b32 v[228:229], v253 offset0:8 offset1:10
ds_read2_b32 v[230:231], v253 offset0:12 offset1:14
s_waitcnt lgkmcnt(6)
v_mfma_f32_32x32x16_bf16 v[192:207], v[232:235], v[104:107], v[192:207]
v_mfma_f32_32x32x16_bf16 v[208:223], v[232:235], v[108:111], v[208:223]
ds_read2_b32 v[232:233], v253 offset0:16 offset1:18
ds_read2_b32 v[234:235], v253 offset0:20 offset1:22
s_waitcnt lgkmcnt(7)
v_mfma_f32_32x32x16_bf16 v[192:207], v[236:239], v[112:115], v[192:207]
v_mfma_f32_32x32x16_bf16 v[208:223], v[236:239], v[116:119], v[208:223]
ds_read2_b32 v[236:237], v253 offset0:24 offset1:26
ds_read2_b32 v[238:239], v253 offset0:28 offset1:30
s_waitcnt lgkmcnt(8)
v_mfma_f32_32x32x16_bf16 v[192:207], v[244:247], v[120:123], v[192:207]
v_mfma_f32_32x32x16_bf16 v[208:223], v[244:247], v[124:127], v[208:223]
ds_read2_b32 v[240:241], v253 offset0:32 offset1:34
ds_read2_b32 v[242:243], v253 offset0:36 offset1:38
s_barrier
s_setprio 0
s_nop 7
v_mul_f32 v208, s37, v208
v_mul_f32 v209, s37, v209
v_mul_f32 v210, s37, v210
v_mul_f32 v211, s37, v211
v_exp_f32 v208, v208
v_exp_f32 v209, v209
v_exp_f32 v210, v210
v_exp_f32 v211, v211
v_fma_f32 v208, v208, s38, s38
v_fma_f32 v209, v209, s38, s38
v_fma_f32 v210, v210, s38, s38
v_fma_f32 v211, v211, s38, s38
v_rcp_f32 v208, v208
v_rcp_f32 v209, v209
v_rcp_f32 v210, v210
v_rcp_f32 v211, v211
v_mul_f32 v192, v192, v208
v_mul_f32 v193, v193, v209
v_mul_f32 v194, v194, v210
v_mul_f32 v195, v195, v211
v_cvt_pk_bf16_f32 v208, v192, v193
v_cvt_pk_bf16_f32 v209, v194, v195
v_mul_f32 v212, s37, v212
v_mul_f32 v213, s37, v213
v_mul_f32 v214, s37, v214
v_mul_f32 v215, s37, v215
v_exp_f32 v212, v212
v_exp_f32 v213, v213
v_exp_f32 v214, v214
v_exp_f32 v215, v215
v_fma_f32 v212, v212, s38, s38
v_fma_f32 v213, v213, s38, s38
v_fma_f32 v214, v214, s38, s38
v_fma_f32 v215, v215, s38, s38
v_rcp_f32 v212, v212
v_rcp_f32 v213, v213
v_rcp_f32 v214, v214
v_rcp_f32 v215, v215
v_mul_f32 v196, v196, v212
v_mul_f32 v197, v197, v213
v_mul_f32 v198, v198, v214
v_mul_f32 v199, v199, v215
v_cvt_pk_bf16_f32 v210, v196, v197
v_cvt_pk_bf16_f32 v211, v198, v199
ds_write_b128 v249, v[208:211] offset:32
ds_read_b128 v[192:195], v250
ds_read_b128 v[212:215], v250 offset:1536
v_mul_f32 v216, s37, v216
v_mul_f32 v217, s37, v217
v_mul_f32 v218, s37, v218
v_mul_f32 v219, s37, v219
v_exp_f32 v216, v216
v_exp_f32 v217, v217
v_exp_f32 v218, v218
v_exp_f32 v219, v219
v_fma_f32 v216, v216, s38, s38
v_fma_f32 v217, v217, s38, s38
v_fma_f32 v218, v218, s38, s38
v_fma_f32 v219, v219, s38, s38
v_rcp_f32 v216, v216
v_rcp_f32 v217, v217
v_rcp_f32 v218, v218
v_rcp_f32 v219, v219
v_mul_f32 v200, v200, v216
v_mul_f32 v201, v201, v217
v_mul_f32 v202, v202, v218
v_mul_f32 v203, v203, v219
v_cvt_pk_bf16_f32 v244, v200, v201
v_cvt_pk_bf16_f32 v245, v202, v203
v_mul_f32 v220, s37, v220
v_mul_f32 v221, s37, v221
v_mul_f32 v222, s37, v222
v_mul_f32 v223, s37, v223
v_exp_f32 v220, v220
v_exp_f32 v221, v221
v_exp_f32 v222, v222
v_exp_f32 v223, v223
v_fma_f32 v220, v220, s38, s38
v_fma_f32 v221, v221, s38, s38
v_fma_f32 v222, v222, s38, s38
v_fma_f32 v223, v223, s38, s38
v_rcp_f32 v220, v220
v_rcp_f32 v221, v221
v_rcp_f32 v222, v222
v_rcp_f32 v223, v223
v_mul_f32 v204, v204, v220
v_mul_f32 v205, v205, v221
v_mul_f32 v206, v206, v222
v_mul_f32 v207, v207, v223
v_cvt_pk_bf16_f32 v246, v204, v205
v_cvt_pk_bf16_f32 v247, v206, v207
ds_write_b128 v249, v[244:247] offset:64
ds_read_b128 v[196:199], v250 offset:16
ds_read_b128 v[216:219], v250 offset:1552
ds_read_b128 v[200:203], v250 offset:32
ds_read_b128 v[220:223], v250 offset:1568
ds_write_b128 v249, v[244:247]
s_waitcnt lgkmcnt(0)
s_setprio 3
v_mfma_f32_4x4x4_16b_bf16 v[204:207], v[224:225], v[192:193], 0
v_mfma_f32_4x4x4_16b_bf16 v[208:211], v[224:225], v[194:195], 0
v_mfma_f32_4x4x4_16b_bf16 v[244:247], v[234:235], v[212:213], 0
v_mfma_f32_4x4x4_16b_bf16 v[204:207], v[226:227], v[194:195], v[204:207]
v_mfma_f32_4x4x4_16b_bf16 v[208:211], v[226:227], v[196:197], v[208:211]
v_mfma_f32_4x4x4_16b_bf16 v[224:227], v[234:235], v[214:215], 0
v_mfma_f32_4x4x4_16b_bf16 v[244:247], v[236:237], v[214:215], v[244:247]
v_mfma_f32_4x4x4_16b_bf16 v[204:207], v[228:229], v[196:197], v[204:207]
v_mfma_f32_4x4x4_16b_bf16 v[224:227], v[236:237], v[216:217], v[224:227]
v_mfma_f32_4x4x4_16b_bf16 v[208:211], v[228:229], v[198:199], v[208:211]
v_mfma_f32_4x4x4_16b_bf16 v[244:247], v[238:239], v[216:217], v[244:247]
v_mfma_f32_4x4x4_16b_bf16 v[204:207], v[230:231], v[198:199], v[204:207]
v_mfma_f32_4x4x4_16b_bf16 v[224:227], v[238:239], v[218:219], v[224:227]
v_mfma_f32_4x4x4_16b_bf16 v[208:211], v[230:231], v[200:201], v[208:211]
v_mfma_f32_4x4x4_16b_bf16 v[244:247], v[240:241], v[218:219], v[244:247]
v_mfma_f32_4x4x4_16b_bf16 v[224:227], v[240:241], v[220:221], v[224:227]
v_mfma_f32_4x4x4_16b_bf16 v[204:207], v[232:233], v[200:201], v[204:207]
v_mfma_f32_4x4x4_16b_bf16 v[208:211], v[232:233], v[202:203], v[208:211]
v_mfma_f32_4x4x4_16b_bf16 v[244:247], v[242:243], v[220:221], v[244:247]
v_mfma_f32_4x4x4_16b_bf16 v[224:227], v[242:243], v[222:223], v[224:227]
s_setprio 0
s_nop 0
v_exp_f32 v192, v204
v_exp_f32 v193, v205
v_exp_f32 v194, v206
v_exp_f32 v195, v207
v_fma_f32 v192, v192, s37, s37
v_fma_f32 v193, v193, s37, s37
v_fma_f32 v194, v194, s37, s37
v_fma_f32 v195, v195, s37, s37
v_rcp_f32 v192, v192
v_rcp_f32 v193, v193
v_rcp_f32 v194, v194
v_rcp_f32 v195, v195
v_mul_f32 v204, v204, v192
v_mul_f32 v205, v205, v193
v_mul_f32 v206, v206, v194
v_mul_f32 v207, v207, v195
v_cvt_pk_bf16_f32 v204, v204, v205
v_cvt_pk_bf16_f32 v205, v206, v207
v_exp_f32 v196, v208
v_exp_f32 v197, v209
v_exp_f32 v198, v210
v_exp_f32 v199, v211
v_fma_f32 v196, v196, s37, s37
v_fma_f32 v197, v197, s37, s37
v_fma_f32 v198, v198, s37, s37
v_fma_f32 v199, v199, s37, s37
v_rcp_f32 v196, v196
v_rcp_f32 v197, v197
v_rcp_f32 v198, v198
v_rcp_f32 v199, v199
v_mul_f32 v208, v208, v196
v_mul_f32 v209, v209, v197
v_mul_f32 v210, v210, v198
v_mul_f32 v211, v211, v199
v_cvt_pk_bf16_f32 v206, v208, v209
v_cvt_pk_bf16_f32 v207, v210, v211
ds_write_b128 v251, v[204:207]
v_exp_f32 v192, v244
v_exp_f32 v193, v245
v_exp_f32 v194, v246
ds_read_b64_tr_b16 v[200:201], v252 offset:16384
ds_read_b64_tr_b16 v[202:203], v252 offset:16640
v_exp_f32 v195, v247
v_fma_f32 v192, v192, s37, s37
v_fma_f32 v193, v193, s37, s37
v_fma_f32 v194, v194, s37, s37
v_fma_f32 v195, v195, s37, s37
ds_read_b64_tr_b16 v[212:213], v252 offset:17408
ds_read_b64_tr_b16 v[214:215], v252 offset:17664
v_rcp_f32 v192, v192
v_rcp_f32 v193, v193
v_rcp_f32 v194, v194
v_rcp_f32 v195, v195
v_mul_f32 v244, v244, v192
ds_read_b64_tr_b16 v[216:217], v252 offset:18432
ds_read_b64_tr_b16 v[218:219], v252 offset:18688
v_mul_f32 v245, v245, v193
v_mul_f32 v246, v246, v194
v_mul_f32 v247, v247, v195
v_cvt_pk_bf16_f32 v244, v244, v245
v_cvt_pk_bf16_f32 v245, v246, v247
ds_read_b64_tr_b16 v[220:221], v252 offset:19456
ds_read_b64_tr_b16 v[222:223], v252 offset:19712
v_exp_f32 v196, v224
v_exp_f32 v197, v225
v_exp_f32 v198, v226
v_exp_f32 v199, v227
v_fma_f32 v196, v196, s37, s37
ds_read_b64_tr_b16 v[204:205], v252 offset:20480
ds_read_b64_tr_b16 v[206:207], v252 offset:20736
v_fma_f32 v197, v197, s37, s37
v_fma_f32 v198, v198, s37, s37
v_fma_f32 v199, v199, s37, s37
v_rcp_f32 v196, v196
v_rcp_f32 v197, v197
ds_read_b64_tr_b16 v[208:209], v252 offset:21504
ds_read_b64_tr_b16 v[210:211], v252 offset:21760
v_rcp_f32 v198, v198
v_rcp_f32 v199, v199
v_mul_f32 v224, v224, v196
v_mul_f32 v225, v225, v197
v_mul_f32 v226, v226, v198
v_mul_f32 v227, v227, v199
v_cvt_pk_bf16_f32 v246, v224, v225
v_cvt_pk_bf16_f32 v247, v226, v227
ds_write_b128 v251, v[244:247] offset:8192
s_setprio 1
s_waitcnt lgkmcnt(11)
v_mfma_f32_32x32x16_bf16 v[224:239], v[128:131], v[200:203], 0
ds_read_b64_tr_b16 v[192:193], v252 offset:22528
ds_read_b64_tr_b16 v[194:195], v252 offset:22784
s_waitcnt lgkmcnt(11)
v_mfma_f32_32x32x16_bf16 v[224:239], v[132:135], v[212:215], v[224:239]
ds_read_b64_tr_b16 v[196:197], v252 offset:23552
ds_read_b64_tr_b16 v[198:199], v252 offset:23808
s_waitcnt lgkmcnt(11)
v_mfma_f32_32x32x16_bf16 v[224:239], v[136:139], v[216:219], v[224:239]
ds_read_b64_tr_b16 v[200:201], v252 offset:24576
ds_read_b64_tr_b16 v[202:203], v252 offset:24832
s_waitcnt lgkmcnt(11)
v_mfma_f32_32x32x16_bf16 v[224:239], v[140:143], v[220:223], v[224:239]
ds_read_b64_tr_b16 v[212:213], v252 offset:25600
ds_read_b64_tr_b16 v[214:215], v252 offset:25856
s_waitcnt lgkmcnt(11)
v_mfma_f32_32x32x16_bf16 v[224:239], v[144:147], v[204:207], v[224:239]
ds_read_b64_tr_b16 v[216:217], v252 offset:26624
ds_read_b64_tr_b16 v[218:219], v252 offset:26880
s_waitcnt lgkmcnt(11)
v_mfma_f32_32x32x16_bf16 v[224:239], v[148:151], v[208:211], v[224:239]
ds_read_b64_tr_b16 v[220:221], v252 offset:27648
ds_read_b64_tr_b16 v[222:223], v252 offset:27904
s_waitcnt lgkmcnt(10)
v_mfma_f32_32x32x16_bf16 v[224:239], v[152:155], v[192:195], v[224:239]
ds_read_b64_tr_b16 v[204:205], v252 offset:28672
ds_read_b64_tr_b16 v[206:207], v252 offset:28928
s_waitcnt lgkmcnt(10)
v_mfma_f32_32x32x16_bf16 v[224:239], v[156:159], v[196:199], v[224:239]
ds_read_b64_tr_b16 v[208:209], v252 offset:29696
ds_read_b64_tr_b16 v[210:211], v252 offset:29952
s_waitcnt lgkmcnt(10)
v_mfma_f32_32x32x16_bf16 v[224:239], v[160:163], v[200:203], v[224:239]
ds_read_b64_tr_b16 v[192:193], v252 offset:30720
ds_read_b64_tr_b16 v[194:195], v252 offset:30976
s_waitcnt lgkmcnt(10)
v_mfma_f32_32x32x16_bf16 v[224:239], v[164:167], v[212:215], v[224:239]
ds_read_b64_tr_b16 v[196:197], v252 offset:31744
ds_read_b64_tr_b16 v[198:199], v252 offset:32000
s_waitcnt lgkmcnt(10)
v_mfma_f32_32x32x16_bf16 v[224:239], v[168:171], v[216:219], v[224:239]
s_waitcnt lgkmcnt(8)
v_mfma_f32_32x32x16_bf16 v[224:239], v[172:175], v[220:223], v[224:239]
s_waitcnt lgkmcnt(6)
v_mfma_f32_32x32x16_bf16 v[224:239], v[176:179], v[204:207], v[224:239]
ds_read_b128 v[240:243], v248
s_waitcnt lgkmcnt(5)
v_mfma_f32_32x32x16_bf16 v[224:239], v[180:183], v[208:211], v[224:239]
ds_read_b128 v[244:247], v248 offset:32
s_waitcnt lgkmcnt(4)
v_mfma_f32_32x32x16_bf16 v[224:239], v[184:187], v[192:195], v[224:239]
s_waitcnt lgkmcnt(2)
v_mfma_f32_32x32x16_bf16 v[224:239], v[188:191], v[196:199], v[224:239]
s_waitcnt lgkmcnt(1)
v_mfma_f32_32x32x16_bf16 v[192:207], v[240:243], v[0:3], 0
v_mfma_f32_32x32x16_bf16 v[208:223], v[240:243], v[4:7], 0
ds_read_b128 v[240:243], v248 offset:64
s_waitcnt lgkmcnt(1)
v_mfma_f32_32x32x16_bf16 v[192:207], v[244:247], v[8:11], v[192:207]
v_mfma_f32_32x32x16_bf16 v[208:223], v[244:247], v[12:15], v[208:223]
ds_read_b128 v[244:247], v248 offset:96
s_nop 3
v_cvt_pk_bf16_f32 v224, v224, v225
v_cvt_pk_bf16_f32 v225, v226, v227
v_cvt_pk_bf16_f32 v226, v228, v229
v_cvt_pk_bf16_f32 v227, v230, v231
s_waitcnt lgkmcnt(1)
v_mfma_f32_32x32x16_bf16 v[192:207], v[240:243], v[16:19], v[192:207]
v_mfma_f32_32x32x16_bf16 v[208:223], v[240:243], v[20:23], v[208:223]
ds_read_b128 v[240:243], v248 offset:128
v_cvt_pk_bf16_f32 v228, v232, v233
v_cvt_pk_bf16_f32 v229, v234, v235
v_cvt_pk_bf16_f32 v230, v236, v237
v_cvt_pk_bf16_f32 v231, v238, v239
v_permlane16_swap_b32 v224, v228
v_permlane16_swap_b32 v225, v229
v_permlane16_swap_b32 v226, v230
v_permlane16_swap_b32 v227, v231
s_mov_b32 s43, 16384
buffer_store_dwordx4 v[224:227], v254, s[32:35], s43 offen sc0 sc1 nt
s_mov_b32 s44, 24576
buffer_store_dwordx4 v[228:231], v254, s[32:35], s44 offen sc0 sc1 nt
ds_read_b128 v[232:235], v248 offset:160
ds_read_b128 v[236:239], v248 offset:192
s_waitcnt lgkmcnt(3)
v_mfma_f32_32x32x16_bf16 v[192:207], v[244:247], v[24:27], v[192:207]
v_mfma_f32_32x32x16_bf16 v[208:223], v[244:247], v[28:31], v[208:223]
ds_read_b128 v[244:247], v248 offset:224
s_waitcnt lgkmcnt(3)
v_mfma_f32_32x32x16_bf16 v[192:207], v[240:243], v[32:35], v[192:207]
v_mfma_f32_32x32x16_bf16 v[208:223], v[240:243], v[36:39], v[208:223]
ds_read_b128 v[240:243], v248 offset:256
s_waitcnt lgkmcnt(3)
v_mfma_f32_32x32x16_bf16 v[192:207], v[232:235], v[40:43], v[192:207]
v_mfma_f32_32x32x16_bf16 v[208:223], v[232:235], v[44:47], v[208:223]
ds_read_b128 v[232:235], v248 offset:288
s_waitcnt lgkmcnt(3)
v_mfma_f32_32x32x16_bf16 v[192:207], v[236:239], v[48:51], v[192:207]
v_mfma_f32_32x32x16_bf16 v[208:223], v[236:239], v[52:55], v[208:223]
ds_read_b128 v[236:239], v248 offset:320
s_waitcnt lgkmcnt(3)
v_mfma_f32_32x32x16_bf16 v[192:207], v[244:247], v[56:59], v[192:207]
v_mfma_f32_32x32x16_bf16 v[208:223], v[244:247], v[60:63], v[208:223]
ds_read_b128 v[244:247], v248 offset:352
s_waitcnt lgkmcnt(3)
v_mfma_f32_32x32x16_bf16 v[192:207], v[240:243], v[64:67], v[192:207]
v_mfma_f32_32x32x16_bf16 v[208:223], v[240:243], v[68:71], v[208:223]
ds_read_b128 v[240:243], v248 offset:384
s_waitcnt lgkmcnt(3)
v_mfma_f32_32x32x16_bf16 v[192:207], v[232:235], v[72:75], v[192:207]
v_mfma_f32_32x32x16_bf16 v[208:223], v[232:235], v[76:79], v[208:223]
ds_read_b128 v[232:235], v248 offset:416
s_waitcnt lgkmcnt(3)
v_mfma_f32_32x32x16_bf16 v[192:207], v[236:239], v[80:83], v[192:207]
v_mfma_f32_32x32x16_bf16 v[208:223], v[236:239], v[84:87], v[208:223]
ds_read_b128 v[236:239], v248 offset:448
s_waitcnt lgkmcnt(3)
v_mfma_f32_32x32x16_bf16 v[192:207], v[244:247], v[88:91], v[192:207]
v_mfma_f32_32x32x16_bf16 v[208:223], v[244:247], v[92:95], v[208:223]
ds_read_b128 v[244:247], v248 offset:480
s_waitcnt lgkmcnt(3)
v_mfma_f32_32x32x16_bf16 v[192:207], v[240:243], v[96:99], v[192:207]
v_mfma_f32_32x32x16_bf16 v[208:223], v[240:243], v[100:103], v[208:223]
ds_read2_b32 v[224:225], v253 offset0:0 offset1:2
ds_read2_b32 v[226:227], v253 offset0:4 offset1:6
ds_read2_b32 v[228:229], v253 offset0:8 offset1:10
ds_read2_b32 v[230:231], v253 offset0:12 offset1:14
s_waitcnt lgkmcnt(6)
v_mfma_f32_32x32x16_bf16 v[192:207], v[232:235], v[104:107], v[192:207]
v_mfma_f32_32x32x16_bf16 v[208:223], v[232:235], v[108:111], v[208:223]
ds_read2_b32 v[232:233], v253 offset0:16 offset1:18
ds_read2_b32 v[234:235], v253 offset0:20 offset1:22
s_waitcnt lgkmcnt(7)
v_mfma_f32_32x32x16_bf16 v[192:207], v[236:239], v[112:115], v[192:207]
v_mfma_f32_32x32x16_bf16 v[208:223], v[236:239], v[116:119], v[208:223]
ds_read2_b32 v[236:237], v253 offset0:24 offset1:26
ds_read2_b32 v[238:239], v253 offset0:28 offset1:30
s_waitcnt lgkmcnt(8)
v_mfma_f32_32x32x16_bf16 v[192:207], v[244:247], v[120:123], v[192:207]
v_mfma_f32_32x32x16_bf16 v[208:223], v[244:247], v[124:127], v[208:223]
ds_read2_b32 v[240:241], v253 offset0:32 offset1:34
ds_read2_b32 v[242:243], v253 offset0:36 offset1:38
s_barrier
s_setprio 0
s_nop 7
v_mul_f32 v208, s37, v208
v_mul_f32 v209, s37, v209
v_mul_f32 v210, s37, v210
v_mul_f32 v211, s37, v211
v_exp_f32 v208, v208
v_exp_f32 v209, v209
v_exp_f32 v210, v210
v_exp_f32 v211, v211
v_fma_f32 v208, v208, s38, s38
v_fma_f32 v209, v209, s38, s38
v_fma_f32 v210, v210, s38, s38
v_fma_f32 v211, v211, s38, s38
v_rcp_f32 v208, v208
v_rcp_f32 v209, v209
v_rcp_f32 v210, v210
v_rcp_f32 v211, v211
v_mul_f32 v192, v192, v208
v_mul_f32 v193, v193, v209
v_mul_f32 v194, v194, v210
v_mul_f32 v195, v195, v211
v_cvt_pk_bf16_f32 v208, v192, v193
v_cvt_pk_bf16_f32 v209, v194, v195
v_mul_f32 v212, s37, v212
v_mul_f32 v213, s37, v213
v_mul_f32 v214, s37, v214
v_mul_f32 v215, s37, v215
v_exp_f32 v212, v212
v_exp_f32 v213, v213
v_exp_f32 v214, v214
v_exp_f32 v215, v215
v_fma_f32 v212, v212, s38, s38
v_fma_f32 v213, v213, s38, s38
v_fma_f32 v214, v214, s38, s38
v_fma_f32 v215, v215, s38, s38
v_rcp_f32 v212, v212
v_rcp_f32 v213, v213
v_rcp_f32 v214, v214
v_rcp_f32 v215, v215
v_mul_f32 v196, v196, v212
v_mul_f32 v197, v197, v213
v_mul_f32 v198, v198, v214
v_mul_f32 v199, v199, v215
v_cvt_pk_bf16_f32 v210, v196, v197
v_cvt_pk_bf16_f32 v211, v198, v199
ds_write_b128 v249, v[208:211] offset:32
ds_read_b128 v[192:195], v250
ds_read_b128 v[212:215], v250 offset:1536
v_mul_f32 v216, s37, v216
v_mul_f32 v217, s37, v217
v_mul_f32 v218, s37, v218
v_mul_f32 v219, s37, v219
v_exp_f32 v216, v216
v_exp_f32 v217, v217
v_exp_f32 v218, v218
v_exp_f32 v219, v219
v_fma_f32 v216, v216, s38, s38
v_fma_f32 v217, v217, s38, s38
v_fma_f32 v218, v218, s38, s38
v_fma_f32 v219, v219, s38, s38
v_rcp_f32 v216, v216
v_rcp_f32 v217, v217
v_rcp_f32 v218, v218
v_rcp_f32 v219, v219
v_mul_f32 v200, v200, v216
v_mul_f32 v201, v201, v217
v_mul_f32 v202, v202, v218
v_mul_f32 v203, v203, v219
v_cvt_pk_bf16_f32 v244, v200, v201
v_cvt_pk_bf16_f32 v245, v202, v203
v_mul_f32 v220, s37, v220
v_mul_f32 v221, s37, v221
v_mul_f32 v222, s37, v222
v_mul_f32 v223, s37, v223
v_exp_f32 v220, v220
v_exp_f32 v221, v221
v_exp_f32 v222, v222
v_exp_f32 v223, v223
v_fma_f32 v220, v220, s38, s38
v_fma_f32 v221, v221, s38, s38
v_fma_f32 v222, v222, s38, s38
v_fma_f32 v223, v223, s38, s38
v_rcp_f32 v220, v220
v_rcp_f32 v221, v221
v_rcp_f32 v222, v222
v_rcp_f32 v223, v223
v_mul_f32 v204, v204, v220
v_mul_f32 v205, v205, v221
v_mul_f32 v206, v206, v222
v_mul_f32 v207, v207, v223
v_cvt_pk_bf16_f32 v246, v204, v205
v_cvt_pk_bf16_f32 v247, v206, v207
ds_write_b128 v249, v[244:247] offset:64
ds_read_b128 v[196:199], v250 offset:16
ds_read_b128 v[216:219], v250 offset:1552
ds_read_b128 v[200:203], v250 offset:32
ds_read_b128 v[220:223], v250 offset:1568
s_waitcnt lgkmcnt(0)
s_setprio 3
v_mfma_f32_4x4x4_16b_bf16 v[204:207], v[224:225], v[192:193], 0
v_mfma_f32_4x4x4_16b_bf16 v[208:211], v[224:225], v[194:195], 0
v_mfma_f32_4x4x4_16b_bf16 v[244:247], v[234:235], v[212:213], 0
v_mfma_f32_4x4x4_16b_bf16 v[204:207], v[226:227], v[194:195], v[204:207]
v_mfma_f32_4x4x4_16b_bf16 v[208:211], v[226:227], v[196:197], v[208:211]
v_mfma_f32_4x4x4_16b_bf16 v[224:227], v[234:235], v[214:215], 0
v_mfma_f32_4x4x4_16b_bf16 v[244:247], v[236:237], v[214:215], v[244:247]
v_mfma_f32_4x4x4_16b_bf16 v[204:207], v[228:229], v[196:197], v[204:207]
v_mfma_f32_4x4x4_16b_bf16 v[224:227], v[236:237], v[216:217], v[224:227]
v_mfma_f32_4x4x4_16b_bf16 v[208:211], v[228:229], v[198:199], v[208:211]
v_mfma_f32_4x4x4_16b_bf16 v[244:247], v[238:239], v[216:217], v[244:247]
v_mfma_f32_4x4x4_16b_bf16 v[204:207], v[230:231], v[198:199], v[204:207]
v_mfma_f32_4x4x4_16b_bf16 v[224:227], v[238:239], v[218:219], v[224:227]
v_mfma_f32_4x4x4_16b_bf16 v[208:211], v[230:231], v[200:201], v[208:211]
v_mfma_f32_4x4x4_16b_bf16 v[244:247], v[240:241], v[218:219], v[244:247]
v_mfma_f32_4x4x4_16b_bf16 v[224:227], v[240:241], v[220:221], v[224:227]
v_mfma_f32_4x4x4_16b_bf16 v[204:207], v[232:233], v[200:201], v[204:207]
v_mfma_f32_4x4x4_16b_bf16 v[208:211], v[232:233], v[202:203], v[208:211]
v_mfma_f32_4x4x4_16b_bf16 v[244:247], v[242:243], v[220:221], v[244:247]
v_mfma_f32_4x4x4_16b_bf16 v[224:227], v[242:243], v[222:223], v[224:227]
s_setprio 0
s_nop 0
v_exp_f32 v192, v204
v_exp_f32 v193, v205
v_exp_f32 v194, v206
v_exp_f32 v195, v207
v_fma_f32 v192, v192, s37, s37
v_fma_f32 v193, v193, s37, s37
v_fma_f32 v194, v194, s37, s37
v_fma_f32 v195, v195, s37, s37
v_rcp_f32 v192, v192
v_rcp_f32 v193, v193
v_rcp_f32 v194, v194
v_rcp_f32 v195, v195
v_mul_f32 v204, v204, v192
v_mul_f32 v205, v205, v193
v_mul_f32 v206, v206, v194
v_mul_f32 v207, v207, v195
v_cvt_pk_bf16_f32 v204, v204, v205
v_cvt_pk_bf16_f32 v205, v206, v207
v_exp_f32 v196, v208
v_exp_f32 v197, v209
v_exp_f32 v198, v210
v_exp_f32 v199, v211
v_fma_f32 v196, v196, s37, s37
v_fma_f32 v197, v197, s37, s37
v_fma_f32 v198, v198, s37, s37
v_fma_f32 v199, v199, s37, s37
v_rcp_f32 v196, v196
v_rcp_f32 v197, v197
v_rcp_f32 v198, v198
v_rcp_f32 v199, v199
v_mul_f32 v208, v208, v196
v_mul_f32 v209, v209, v197
v_mul_f32 v210, v210, v198
v_mul_f32 v211, v211, v199
v_cvt_pk_bf16_f32 v206, v208, v209
v_cvt_pk_bf16_f32 v207, v210, v211
ds_write_b128 v251, v[204:207] offset:16384
v_exp_f32 v192, v244
v_exp_f32 v193, v245
v_exp_f32 v194, v246
ds_read_b64_tr_b16 v[200:201], v252
ds_read_b64_tr_b16 v[202:203], v252 offset:256
v_exp_f32 v195, v247
v_fma_f32 v192, v192, s37, s37
v_fma_f32 v193, v193, s37, s37
v_fma_f32 v194, v194, s37, s37
v_fma_f32 v195, v195, s37, s37
ds_read_b64_tr_b16 v[212:213], v252 offset:1024
ds_read_b64_tr_b16 v[214:215], v252 offset:1280
v_rcp_f32 v192, v192
v_rcp_f32 v193, v193
v_rcp_f32 v194, v194
v_rcp_f32 v195, v195
v_mul_f32 v244, v244, v192
ds_read_b64_tr_b16 v[216:217], v252 offset:2048
ds_read_b64_tr_b16 v[218:219], v252 offset:2304
v_mul_f32 v245, v245, v193
v_mul_f32 v246, v246, v194
v_mul_f32 v247, v247, v195
v_cvt_pk_bf16_f32 v244, v244, v245
v_cvt_pk_bf16_f32 v245, v246, v247
ds_read_b64_tr_b16 v[220:221], v252 offset:3072
ds_read_b64_tr_b16 v[222:223], v252 offset:3328
v_exp_f32 v196, v224
v_exp_f32 v197, v225
v_exp_f32 v198, v226
v_exp_f32 v199, v227
v_fma_f32 v196, v196, s37, s37
ds_read_b64_tr_b16 v[204:205], v252 offset:4096
ds_read_b64_tr_b16 v[206:207], v252 offset:4352
v_fma_f32 v197, v197, s37, s37
v_fma_f32 v198, v198, s37, s37
v_fma_f32 v199, v199, s37, s37
v_rcp_f32 v196, v196
v_rcp_f32 v197, v197
ds_read_b64_tr_b16 v[208:209], v252 offset:5120
ds_read_b64_tr_b16 v[210:211], v252 offset:5376
v_rcp_f32 v198, v198
v_rcp_f32 v199, v199
v_mul_f32 v224, v224, v196
v_mul_f32 v225, v225, v197
v_mul_f32 v226, v226, v198
v_mul_f32 v227, v227, v199
v_cvt_pk_bf16_f32 v246, v224, v225
v_cvt_pk_bf16_f32 v247, v226, v227
ds_write_b128 v251, v[244:247] offset:24576
s_setprio 1
s_waitcnt lgkmcnt(11)
v_mfma_f32_32x32x16_bf16 v[224:239], v[128:131], v[200:203], 0
ds_read_b64_tr_b16 v[192:193], v252 offset:6144
ds_read_b64_tr_b16 v[194:195], v252 offset:6400
s_waitcnt lgkmcnt(11)
v_mfma_f32_32x32x16_bf16 v[224:239], v[132:135], v[212:215], v[224:239]
ds_read_b64_tr_b16 v[196:197], v252 offset:7168
ds_read_b64_tr_b16 v[198:199], v252 offset:7424
s_waitcnt lgkmcnt(11)
v_mfma_f32_32x32x16_bf16 v[224:239], v[136:139], v[216:219], v[224:239]
ds_read_b64_tr_b16 v[200:201], v252 offset:8192
ds_read_b64_tr_b16 v[202:203], v252 offset:8448
s_waitcnt lgkmcnt(11)
v_mfma_f32_32x32x16_bf16 v[224:239], v[140:143], v[220:223], v[224:239]
ds_read_b64_tr_b16 v[212:213], v252 offset:9216
ds_read_b64_tr_b16 v[214:215], v252 offset:9472
s_waitcnt lgkmcnt(11)
v_mfma_f32_32x32x16_bf16 v[224:239], v[144:147], v[204:207], v[224:239]
ds_read_b64_tr_b16 v[216:217], v252 offset:10240
ds_read_b64_tr_b16 v[218:219], v252 offset:10496
s_waitcnt lgkmcnt(11)
v_mfma_f32_32x32x16_bf16 v[224:239], v[148:151], v[208:211], v[224:239]
ds_read_b64_tr_b16 v[220:221], v252 offset:11264
ds_read_b64_tr_b16 v[222:223], v252 offset:11520
s_waitcnt lgkmcnt(10)
v_mfma_f32_32x32x16_bf16 v[224:239], v[152:155], v[192:195], v[224:239]
ds_read_b64_tr_b16 v[204:205], v252 offset:12288
ds_read_b64_tr_b16 v[206:207], v252 offset:12544
s_waitcnt lgkmcnt(10)
v_mfma_f32_32x32x16_bf16 v[224:239], v[156:159], v[196:199], v[224:239]
ds_read_b64_tr_b16 v[208:209], v252 offset:13312
ds_read_b64_tr_b16 v[210:211], v252 offset:13568
s_waitcnt lgkmcnt(10)
v_mfma_f32_32x32x16_bf16 v[224:239], v[160:163], v[200:203], v[224:239]
ds_read_b64_tr_b16 v[192:193], v252 offset:14336
ds_read_b64_tr_b16 v[194:195], v252 offset:14592
s_waitcnt lgkmcnt(10)
v_mfma_f32_32x32x16_bf16 v[224:239], v[164:167], v[212:215], v[224:239]
ds_read_b64_tr_b16 v[196:197], v252 offset:15360
ds_read_b64_tr_b16 v[198:199], v252 offset:15616
s_waitcnt lgkmcnt(10)
v_mfma_f32_32x32x16_bf16 v[224:239], v[168:171], v[216:219], v[224:239]
s_waitcnt lgkmcnt(8)
v_mfma_f32_32x32x16_bf16 v[224:239], v[172:175], v[220:223], v[224:239]
s_waitcnt lgkmcnt(6)
v_mfma_f32_32x32x16_bf16 v[224:239], v[176:179], v[204:207], v[224:239]
s_waitcnt lgkmcnt(4)
v_mfma_f32_32x32x16_bf16 v[224:239], v[180:183], v[208:211], v[224:239]
s_waitcnt lgkmcnt(2)
v_mfma_f32_32x32x16_bf16 v[224:239], v[184:187], v[192:195], v[224:239]
s_waitcnt lgkmcnt(0)
v_mfma_f32_32x32x16_bf16 v[224:239], v[188:191], v[196:199], v[224:239]
s_nop 11
v_cvt_pk_bf16_f32 v224, v224, v225
v_cvt_pk_bf16_f32 v225, v226, v227
v_cvt_pk_bf16_f32 v226, v228, v229
v_cvt_pk_bf16_f32 v227, v230, v231
v_cvt_pk_bf16_f32 v228, v232, v233
v_cvt_pk_bf16_f32 v229, v234, v235
v_cvt_pk_bf16_f32 v230, v236, v237
v_cvt_pk_bf16_f32 v231, v238, v239
v_permlane16_swap_b32 v224, v228
v_permlane16_swap_b32 v225, v229
v_permlane16_swap_b32 v226, v230
v_permlane16_swap_b32 v227, v231
s_mov_b32 s42, 32768
buffer_store_dwordx4 v[224:227], v254, s[32:35], s42 offen sc0 sc1 nt
s_mov_b32 s43, 40960
buffer_store_dwordx4 v[228:231], v254, s[32:35], s43 offen sc0 sc1 nt
s_barrier
ds_read_b64_tr_b16 v[200:201], v252 offset:16384
ds_read_b64_tr_b16 v[202:203], v252 offset:16640
ds_read_b64_tr_b16 v[212:213], v252 offset:17408
ds_read_b64_tr_b16 v[214:215], v252 offset:17664
ds_read_b64_tr_b16 v[216:217], v252 offset:18432
ds_read_b64_tr_b16 v[218:219], v252 offset:18688
ds_read_b64_tr_b16 v[220:221], v252 offset:19456
ds_read_b64_tr_b16 v[222:223], v252 offset:19712
ds_read_b64_tr_b16 v[204:205], v252 offset:20480
ds_read_b64_tr_b16 v[206:207], v252 offset:20736
ds_read_b64_tr_b16 v[208:209], v252 offset:21504
ds_read_b64_tr_b16 v[210:211], v252 offset:21760
s_waitcnt lgkmcnt(10)
v_mfma_f32_32x32x16_bf16 v[224:239], v[128:131], v[200:203], 0
ds_read_b64_tr_b16 v[192:193], v252 offset:22528
ds_read_b64_tr_b16 v[194:195], v252 offset:22784
s_waitcnt lgkmcnt(10)
v_mfma_f32_32x32x16_bf16 v[224:239], v[132:135], v[212:215], v[224:239]
ds_read_b64_tr_b16 v[196:197], v252 offset:23552
ds_read_b64_tr_b16 v[198:199], v252 offset:23808
s_waitcnt lgkmcnt(10)
v_mfma_f32_32x32x16_bf16 v[224:239], v[136:139], v[216:219], v[224:239]
ds_read_b64_tr_b16 v[200:201], v252 offset:24576
ds_read_b64_tr_b16 v[202:203], v252 offset:24832
s_waitcnt lgkmcnt(10)
v_mfma_f32_32x32x16_bf16 v[224:239], v[140:143], v[220:223], v[224:239]
ds_read_b64_tr_b16 v[212:213], v252 offset:25600
ds_read_b64_tr_b16 v[214:215], v252 offset:25856
s_waitcnt lgkmcnt(10)
v_mfma_f32_32x32x16_bf16 v[224:239], v[144:147], v[204:207], v[224:239]
ds_read_b64_tr_b16 v[216:217], v252 offset:26624
ds_read_b64_tr_b16 v[218:219], v252 offset:26880
s_waitcnt lgkmcnt(10)
v_mfma_f32_32x32x16_bf16 v[224:239], v[148:151], v[208:211], v[224:239]
ds_read_b64_tr_b16 v[220:221], v252 offset:27648
ds_read_b64_tr_b16 v[222:223], v252 offset:27904
s_waitcnt lgkmcnt(10)
v_mfma_f32_32x32x16_bf16 v[224:239], v[152:155], v[192:195], v[224:239]
ds_read_b64_tr_b16 v[204:205], v252 offset:28672
ds_read_b64_tr_b16 v[206:207], v252 offset:28928
s_waitcnt lgkmcnt(10)
v_mfma_f32_32x32x16_bf16 v[224:239], v[156:159], v[196:199], v[224:239]
ds_read_b64_tr_b16 v[208:209], v252 offset:29696
ds_read_b64_tr_b16 v[210:211], v252 offset:29952
s_waitcnt lgkmcnt(10)
v_mfma_f32_32x32x16_bf16 v[224:239], v[160:163], v[200:203], v[224:239]
ds_read_b64_tr_b16 v[192:193], v252 offset:30720
ds_read_b64_tr_b16 v[194:195], v252 offset:30976
s_waitcnt lgkmcnt(10)
v_mfma_f32_32x32x16_bf16 v[224:239], v[164:167], v[212:215], v[224:239]
ds_read_b64_tr_b16 v[196:197], v252 offset:31744
ds_read_b64_tr_b16 v[198:199], v252 offset:32000
s_waitcnt lgkmcnt(10)
v_mfma_f32_32x32x16_bf16 v[224:239], v[168:171], v[216:219], v[224:239]
s_waitcnt lgkmcnt(8)
v_mfma_f32_32x32x16_bf16 v[224:239], v[172:175], v[220:223], v[224:239]
s_waitcnt lgkmcnt(6)
v_mfma_f32_32x32x16_bf16 v[224:239], v[176:179], v[204:207], v[224:239]
s_waitcnt lgkmcnt(4)
v_mfma_f32_32x32x16_bf16 v[224:239], v[180:183], v[208:211], v[224:239]
s_waitcnt lgkmcnt(2)
v_mfma_f32_32x32x16_bf16 v[224:239], v[184:187], v[192:195], v[224:239]
s_waitcnt lgkmcnt(0)
v_mfma_f32_32x32x16_bf16 v[224:239], v[188:191], v[196:199], v[224:239]
s_nop 11
v_cvt_pk_bf16_f32 v224, v224, v225
v_cvt_pk_bf16_f32 v225, v226, v227
v_cvt_pk_bf16_f32 v226, v228, v229
v_cvt_pk_bf16_f32 v227, v230, v231
v_cvt_pk_bf16_f32 v228, v232, v233
v_cvt_pk_bf16_f32 v229, v234, v235
v_cvt_pk_bf16_f32 v230, v236, v237
v_cvt_pk_bf16_f32 v231, v238, v239
v_permlane16_swap_b32 v224, v228
v_permlane16_swap_b32 v225, v229
v_permlane16_swap_b32 v226, v230
v_permlane16_swap_b32 v227, v231
s_mov_b32 s44, 49152
buffer_store_dwordx4 v[224:227], v254, s[32:35], s44 offen sc0 sc1 nt
s_mov_b32 s42, 57344
buffer_store_dwordx4 v[228:231], v254, s[32:35], s42 offen sc0 sc1 nt
s_endpgm
.p2align 6
L_late:
s_setprio 3
s_waitcnt lgkmcnt(0)
s_add_u32 s16, s4, s46
s_addc_u32 s17, s5, 0
s_mov_b32 s20, s6
s_mov_b32 s21, s7
s_mov_b32 s28, s8
s_mov_b32 s29, s9
s_mov_b32 s24, s10
s_mov_b32 s25, s11
s_add_u32 s32, s12, s47
s_addc_u32 s33, s13, 0
s_lshl_b32 s48, s100, 9
v_lshl_add_u32 v17, v0, 3, s48
s_mov_b32 s48, L_end-standalone__conformer_conv_module__speech_kernel-8
v_min_u32 v17, s48, v17
s_getpc_b64 s[46:47]
L_pc:
s_sub_u32 s46, s46, L_pc-standalone__conformer_conv_module__speech_kernel
s_subb_u32 s47, s47, 0
v_mov_b32 v19, s47
v_add_co_u32 v18, vcc, s46, v17
s_nop 1
v_addc_co_u32 v19, vcc, 0, v19, vcc
global_load_dwordx2 v[32:33], v[18:19], off
s_lshl_b32 s43, s36, 11
s_add_u32 m0, s43, 49984
s_nop 0
buffer_load_dwordx4 v191, s[28:31], 0 offen lds
v_and_b32 v5, 15, v0
v_bfe_u32 v6, v0, 4, 1
v_mul_u32_u24 v248, 0x410, v5
v_lshl_add_u32 v248, v6, 9, v248
v_lshl_add_u32 v248, v2, 4, v248
v_lshrrev_b32 v7, 2, v5
v_lshlrev_b32 v9, 9, v2
v_lshl_add_u32 v9, v7, 6, v9
v_lshl_add_u32 v9, v6, 5, v9
v_lshl_add_u32 v12, v8, 3, v9
v_add_u32 v252, 0x10400, v12
v_add_u32 v185, s41, v12
v_add_u32 v160, s45, v12
s_lshl_b32 s48, s36, 11
s_add_u32 s48, s48, 49920
v_add_u32 v186, s48, v12
v_and_b32 v13, 1, v0
v_lshl_add_u32 v13, v13, 4, v9
v_bfe_u32 v14, v0, 1, 1
v_lshl_add_u32 v13, v14, 3, v13
v_add_u32 v189, s41, v13
v_lshl_add_u32 v251, v0, 4, s41
v_lshrrev_b32 v13, 1, v3
v_lshrrev_b32 v14, 2, v3
v_xor_b32 v13, v13, v14
v_and_b32 v13, 1, v13
v_xor_b32 v13, v13, v3
v_mul_u32_u24 v13, 0x60, v13
v_lshl_add_u32 v13, v2, 4, v13
v_add_u32 v249, s45, v13
v_lshrrev_b32 v13, 1, v10
v_lshrrev_b32 v14, 2, v10
v_xor_b32 v13, v13, v14
v_and_b32 v13, 1, v13
v_xor_b32 v13, v13, v10
v_mul_u32_u24 v13, 0x60, v13
v_lshl_add_u32 v13, v8, 4, v13
v_add_u32 v250, s45, v13
s_mul_i32 s48, s36, 2816
s_add_u32 s48, s48, 140288
v_mul_u32_u24 v13, 0xb0, v10
v_lshlrev_b32 v14, 2, v8
v_sub_u32 v13, v13, v14
v_add3_u32 v253, v13, s48, 12
v_mul_u32_u24 v13, 0xb0, v5
v_add_u32 v13, s48, v13
v_mul_u32_u24 v14, 0x50, v6
v_lshl_add_u32 v161, v2, 5, v14
v_add3_u32 v161, v161, v13, 16
v_mul_u32_u24 v15, 0xa0, v2
v_max_u32 v14, v14, v15
v_add_u32 v162, v13, v14
s_lshl_b32 s48, s36, 11
s_add_u32 s48, s48, 49920
v_lshl_add_u32 v14, v8, 4, s48
v_cmp_lt_u32 vcc, 47, v0
s_nop 1
v_cndmask_b32 v162, v162, v14, vcc
v_lshl_add_u32 v13, v2, 4, s49
v_lshl_add_u32 v13, v6, 5, v13
v_lshl_add_u32 v254, v5, 9, v13
v_mov_b32 v164, 0
v_mov_b32 v165, 0
v_mov_b32 v166, 0
v_mov_b32 v167, 0
s_sub_u32 s47, s40, s41
v_add_u32 v190, s47, v189
s_add_u32 s47, s47, 33280
v_add_u32 v187, s47, v185
s_lshl_b32 s48, s100, 11
v_lshlrev_b32 v188, 4, v0
buffer_load_dwordx4 v[176:179], v188, s[20:23], s48 offen
buffer_load_dwordx4 v[180:183], v188, s[20:23], s48 offen offset:1024
ds_write_b128 v162, v[164:167]
s_waitcnt vmcnt(2)
ds_read_b64_tr_b16 v[168:169], v186
ds_read_b64_tr_b16 v[170:171], v186 offset:64
ds_read_b64_tr_b16 v[172:173], v186 offset:256
ds_read_b64_tr_b16 v[174:175], v186 offset:320
s_waitcnt lgkmcnt(2)
v_swap_b32 v169, v170
s_waitcnt lgkmcnt(0)
v_swap_b32 v173, v174
ds_write_b128 v161, v[168:171]
ds_write_b128 v161, v[172:175] offset:16
s_waitcnt lgkmcnt(0)
s_barrier
s_setprio 0
s_barrier
s_setprio 2
s_add_u32 m0, s41, 24576
s_nop 0
buffer_load_dwordx4 v184, s[20:23], 0 offen lds
s_mov_b32 m0, s41
s_mov_b32 s44, 512
buffer_load_dwordx4 v184, s[20:23], s44 offen lds
s_add_u32 m0, s41, 8192
s_mov_b32 s42, 16384
buffer_load_dwordx4 v184, s[20:23], s42 offen lds
s_mov_b32 m0, s45
s_mov_b32 s43, 16896
buffer_load_dwordx4 v184, s[20:23], s43 offen lds
s_add_u32 m0, s45, 1024
s_mov_b32 s44, 32768
buffer_load_dwordx4 v184, s[20:23], s44 offen lds
s_add_u32 m0, s45, 2048
s_mov_b32 s42, 33280
buffer_load_dwordx4 v184, s[20:23], s42 offen lds
s_add_u32 m0, s40, 33280
s_mov_b32 s43, 49152
buffer_load_dwordx4 v184, s[20:23], s43 offen lds
s_add_u32 m0, s40, 37440
s_mov_b32 s44, 49664
buffer_load_dwordx4 v184, s[20:23], s44 offen lds
s_add_u32 m0, s40, 41600
s_mov_b32 s42, 65536
buffer_load_dwordx4 v184, s[20:23], s42 offen lds
s_add_u32 m0, s40, 45760
s_mov_b32 s43, 66048
buffer_load_dwordx4 v184, s[20:23], s43 offen lds
s_add_u32 m0, s41, 32768
s_mov_b32 s44, 81920
buffer_load_dwordx4 v184, s[20:23], s44 offen lds
s_add_u32 m0, s41, 40960
s_mov_b32 s42, 82432
buffer_load_dwordx4 v184, s[20:23], s42 offen lds
s_add_u32 m0, s41, 16384
s_mov_b32 s43, 98304
buffer_load_dwordx4 v184, s[20:23], s43 offen lds
s_waitcnt vmcnt(11)
ds_read_b64_tr_b16 v[0:1], v185 offset:24576
ds_read_b64_tr_b16 v[2:3], v185 offset:24832
ds_read_b64_tr_b16 v[4:5], v185
ds_read_b64_tr_b16 v[6:7], v185 offset:256
ds_read_b128 v[224:227], v248
ds_read_b128 v[228:231], v248 offset:16640
s_waitcnt vmcnt(9)
ds_read_b64_tr_b16 v[8:9], v185 offset:8192
ds_read_b64_tr_b16 v[10:11], v185 offset:8448
ds_read_b64_tr_b16 v[12:13], v160
ds_read_b64_tr_b16 v[14:15], v160 offset:256
ds_read_b128 v[232:235], v248 offset:32
ds_read_b128 v[236:239], v248 offset:16672
s_waitcnt lgkmcnt(8)
s_add_u32 m0, s41, 24576
s_mov_b32 s44, 98816
buffer_load_dwordx4 v184, s[20:23], s44 offen lds
s_mov_b32 m0, s41
s_mov_b32 s42, 114688
buffer_load_dwordx4 v184, s[20:23], s42 offen lds
s_waitcnt lgkmcnt(7)
v_mfma_f32_32x32x16_bf16 v[128:143], v[224:227], v[0:3], 0
s_waitcnt lgkmcnt(2)
s_add_u32 m0, s41, 8192
s_mov_b32 s43, 115200
buffer_load_dwordx4 v184, s[20:23], s43 offen lds
v_mfma_f32_32x32x16_bf16 v[144:159], v[224:227], v[4:7], 0
s_mov_b32 m0, s45
s_mov_b32 s44, 131072
buffer_load_dwordx4 v184, s[20:23], s44 offen lds
v_mfma_f32_32x32x16_bf16 v[192:207], v[228:231], v[0:3], 0
s_waitcnt vmcnt(11)
ds_read_b64_tr_b16 v[16:17], v160 offset:1024
ds_read_b64_tr_b16 v[18:19], v160 offset:1280
ds_read_b64_tr_b16 v[20:21], v160 offset:2048
ds_read_b64_tr_b16 v[22:23], v160 offset:2304
v_mfma_f32_32x32x16_bf16 v[208:223], v[228:231], v[4:7], 0
ds_read_b128 v[240:243], v248 offset:64
ds_read_b128 v[244:247], v248 offset:16704
s_waitcnt lgkmcnt(7)
v_mfma_f32_32x32x16_bf16 v[128:143], v[232:235], v[8:11], v[128:143]
s_waitcnt lgkmcnt(2)
s_add_u32 m0, s45, 1024
s_mov_b32 s42, 131584
buffer_load_dwordx4 v184, s[20:23], s42 offen lds
v_mfma_f32_32x32x16_bf16 v[144:159], v[232:235], v[12:15], v[144:159]
s_add_u32 m0, s45, 2048
s_mov_b32 s43, 147456
buffer_load_dwordx4 v184, s[20:23], s43 offen lds
v_mfma_f32_32x32x16_bf16 v[192:207], v[236:239], v[8:11], v[192:207]
s_waitcnt vmcnt(11)
ds_read_b64_tr_b16 v[24:25], v187
ds_read_b64_tr_b16 v[26:27], v187 offset:256
ds_read_b64_tr_b16 v[28:29], v187 offset:4160
ds_read_b64_tr_b16 v[30:31], v187 offset:4416
v_mfma_f32_32x32x16_bf16 v[208:223], v[236:239], v[12:15], v[208:223]
ds_read_b128 v[224:227], v248 offset:96
ds_read_b128 v[228:231], v248 offset:16736
s_waitcnt lgkmcnt(7)
v_mfma_f32_32x32x16_bf16 v[128:143], v[240:243], v[16:19], v[128:143]
s_waitcnt lgkmcnt(2)
s_add_u32 m0, s40, 33280
s_mov_b32 s44, 147968
buffer_load_dwordx4 v184, s[20:23], s44 offen lds
v_mfma_f32_32x32x16_bf16 v[144:159], v[240:243], v[20:23], v[144:159]
s_add_u32 m0, s40, 37440
s_mov_b32 s42, 163840
buffer_load_dwordx4 v184, s[20:23], s42 offen lds
v_mfma_f32_32x32x16_bf16 v[192:207], v[244:247], v[16:19], v[192:207]
s_waitcnt vmcnt(11)
ds_read_b64_tr_b16 v[32:33], v187 offset:8320
ds_read_b64_tr_b16 v[34:35], v187 offset:8576
ds_read_b64_tr_b16 v[36:37], v187 offset:12480
ds_read_b64_tr_b16 v[38:39], v187 offset:12736
v_mfma_f32_32x32x16_bf16 v[208:223], v[244:247], v[20:23], v[208:223]
ds_read_b128 v[232:235], v248 offset:128
ds_read_b128 v[236:239], v248 offset:16768
s_waitcnt lgkmcnt(7)
v_mfma_f32_32x32x16_bf16 v[128:143], v[224:227], v[24:27], v[128:143]
s_waitcnt lgkmcnt(2)
s_add_u32 m0, s40, 41600
s_mov_b32 s43, 164352
buffer_load_dwordx4 v184, s[20:23], s43 offen lds
v_mfma_f32_32x32x16_bf16 v[144:159], v[224:227], v[28:31], v[144:159]
s_add_u32 m0, s40, 45760
s_mov_b32 s44, 180224
buffer_load_dwordx4 v184, s[20:23], s44 offen lds
v_mfma_f32_32x32x16_bf16 v[192:207], v[228:231], v[24:27], v[192:207]
s_waitcnt vmcnt(11)
ds_read_b64_tr_b16 v[40:41], v185 offset:32768
ds_read_b64_tr_b16 v[42:43], v185 offset:33024
ds_read_b64_tr_b16 v[44:45], v185 offset:40960
ds_read_b64_tr_b16 v[46:47], v185 offset:41216
v_mfma_f32_32x32x16_bf16 v[208:223], v[228:231], v[28:31], v[208:223]
ds_read_b128 v[240:243], v248 offset:160
ds_read_b128 v[244:247], v248 offset:16800
s_waitcnt lgkmcnt(7)
v_mfma_f32_32x32x16_bf16 v[128:143], v[232:235], v[32:35], v[128:143]
s_waitcnt lgkmcnt(2)
s_add_u32 m0, s41, 32768
s_mov_b32 s42, 180736
buffer_load_dwordx4 v184, s[20:23], s42 offen lds
v_mfma_f32_32x32x16_bf16 v[144:159], v[232:235], v[36:39], v[144:159]
s_add_u32 m0, s41, 40960
s_mov_b32 s43, 196608
buffer_load_dwordx4 v184, s[20:23], s43 offen lds
v_mfma_f32_32x32x16_bf16 v[192:207], v[236:239], v[32:35], v[192:207]
s_waitcnt vmcnt(11)
ds_read_b64_tr_b16 v[48:49], v185 offset:16384
ds_read_b64_tr_b16 v[50:51], v185 offset:16640
ds_read_b64_tr_b16 v[52:53], v185 offset:24576
ds_read_b64_tr_b16 v[54:55], v185 offset:24832
v_mfma_f32_32x32x16_bf16 v[208:223], v[236:239], v[36:39], v[208:223]
ds_read_b128 v[224:227], v248 offset:192
ds_read_b128 v[228:231], v248 offset:16832
s_waitcnt lgkmcnt(7)
v_mfma_f32_32x32x16_bf16 v[128:143], v[240:243], v[40:43], v[128:143]
s_waitcnt lgkmcnt(2)
s_add_u32 m0, s41, 16384
s_mov_b32 s44, 197120
buffer_load_dwordx4 v184, s[20:23], s44 offen lds
v_mfma_f32_32x32x16_bf16 v[144:159], v[240:243], v[44:47], v[144:159]
s_add_u32 m0, s41, 24576
s_mov_b32 s42, 212992
buffer_load_dwordx4 v184, s[20:23], s42 offen lds
v_mfma_f32_32x32x16_bf16 v[192:207], v[244:247], v[40:43], v[192:207]
s_waitcnt vmcnt(11)
ds_read_b64_tr_b16 v[56:57], v185
ds_read_b64_tr_b16 v[58:59], v185 offset:256
ds_read_b64_tr_b16 v[60:61], v185 offset:8192
ds_read_b64_tr_b16 v[62:63], v185 offset:8448
v_mfma_f32_32x32x16_bf16 v[208:223], v[244:247], v[44:47], v[208:223]
ds_read_b128 v[232:235], v248 offset:224
ds_read_b128 v[236:239], v248 offset:16864
s_waitcnt lgkmcnt(7)
v_mfma_f32_32x32x16_bf16 v[128:143], v[224:227], v[48:51], v[128:143]
s_waitcnt lgkmcnt(2)
s_mov_b32 m0, s41
s_mov_b32 s43, 213504
buffer_load_dwordx4 v184, s[20:23], s43 offen lds
v_mfma_f32_32x32x16_bf16 v[144:159], v[224:227], v[52:55], v[144:159]
s_add_u32 m0, s41, 8192
s_mov_b32 s44, 229376
buffer_load_dwordx4 v184, s[20:23], s44 offen lds
v_mfma_f32_32x32x16_bf16 v[192:207], v[228:231], v[48:51], v[192:207]
s_waitcnt vmcnt(11)
ds_read_b64_tr_b16 v[64:65], v160
ds_read_b64_tr_b16 v[66:67], v160 offset:256
ds_read_b64_tr_b16 v[68:69], v160 offset:1024
ds_read_b64_tr_b16 v[70:71], v160 offset:1280
v_mfma_f32_32x32x16_bf16 v[208:223], v[228:231], v[52:55], v[208:223]
ds_read_b128 v[240:243], v248 offset:256
ds_read_b128 v[244:247], v248 offset:16896
s_waitcnt lgkmcnt(7)
v_mfma_f32_32x32x16_bf16 v[128:143], v[232:235], v[56:59], v[128:143]
s_waitcnt lgkmcnt(2)
s_mov_b32 m0, s45
s_mov_b32 s42, 229888
buffer_load_dwordx4 v184, s[20:23], s42 offen lds
v_mfma_f32_32x32x16_bf16 v[144:159], v[232:235], v[60:63], v[144:159]
s_add_u32 m0, s45, 1024
s_mov_b32 s43, 245760
buffer_load_dwordx4 v184, s[20:23], s43 offen lds
v_mfma_f32_32x32x16_bf16 v[192:207], v[236:239], v[56:59], v[192:207]
s_waitcnt vmcnt(11)
ds_read_b64_tr_b16 v[72:73], v160 offset:2048
ds_read_b64_tr_b16 v[74:75], v160 offset:2304
ds_read_b64_tr_b16 v[76:77], v187
ds_read_b64_tr_b16 v[78:79], v187 offset:256
v_mfma_f32_32x32x16_bf16 v[208:223], v[236:239], v[60:63], v[208:223]
ds_read_b128 v[224:227], v248 offset:288
ds_read_b128 v[228:231], v248 offset:16928
s_waitcnt lgkmcnt(7)
v_mfma_f32_32x32x16_bf16 v[128:143], v[240:243], v[64:67], v[128:143]
s_waitcnt lgkmcnt(2)
s_add_u32 m0, s45, 2048
s_mov_b32 s44, 246272
buffer_load_dwordx4 v184, s[20:23], s44 offen lds
v_mfma_f32_32x32x16_bf16 v[144:159], v[240:243], v[68:71], v[144:159]
s_lshl_b32 s42, s100, 10
v_lshlrev_b32 v188, 4, v0
buffer_load_dwordx4 v[180:183], v188, s[24:27], s42 offen
s_add_u32 m0, s40, 33280
s_add_u32 s43, s39, 32768
buffer_load_dwordx4 v255, s[16:19], s43 offen nt lds
v_mfma_f32_32x32x16_bf16 v[192:207], v[244:247], v[64:67], v[192:207]
s_waitcnt vmcnt(12)
ds_read_b64_tr_b16 v[80:81], v187 offset:4160
ds_read_b64_tr_b16 v[82:83], v187 offset:4416
ds_read_b64_tr_b16 v[84:85], v187 offset:8320
ds_read_b64_tr_b16 v[86:87], v187 offset:8576
v_mfma_f32_32x32x16_bf16 v[208:223], v[244:247], v[68:71], v[208:223]
ds_read_b128 v[232:235], v248 offset:320
ds_read_b128 v[236:239], v248 offset:16960
s_waitcnt lgkmcnt(7)
v_mfma_f32_32x32x16_bf16 v[128:143], v[224:227], v[72:75], v[128:143]
s_waitcnt lgkmcnt(2)
s_add_u32 m0, s40, 37440
s_add_u32 s44, s39, 36864
buffer_load_dwordx4 v255, s[16:19], s44 offen nt lds
v_mfma_f32_32x32x16_bf16 v[144:159], v[224:227], v[76:79], v[144:159]
s_add_u32 m0, s40, 41600
s_add_u32 s42, s39, 34816
buffer_load_dwordx4 v255, s[16:19], s42 offen nt lds
v_mfma_f32_32x32x16_bf16 v[192:207], v[228:231], v[72:75], v[192:207]
s_waitcnt vmcnt(12)
ds_read_b64_tr_b16 v[88:89], v187 offset:12480
ds_read_b64_tr_b16 v[90:91], v187 offset:12736
ds_read_b64_tr_b16 v[92:93], v185 offset:32768
ds_read_b64_tr_b16 v[94:95], v185 offset:33024
v_mfma_f32_32x32x16_bf16 v[208:223], v[228:231], v[76:79], v[208:223]
ds_read_b128 v[240:243], v248 offset:352
ds_read_b128 v[244:247], v248 offset:16992
s_waitcnt lgkmcnt(7)
v_mfma_f32_32x32x16_bf16 v[128:143], v[232:235], v[80:83], v[128:143]
s_waitcnt lgkmcnt(2)
s_add_u32 m0, s40, 45760
s_add_u32 s43, s39, 38912
buffer_load_dwordx4 v255, s[16:19], s43 offen nt lds
v_mfma_f32_32x32x16_bf16 v[144:159], v[232:235], v[84:87], v[144:159]
s_add_u32 m0, s40, 49920
s_nop 0
buffer_load_dwordx4 v191, s[24:27], 0 offen lds
v_mfma_f32_32x32x16_bf16 v[192:207], v[236:239], v[80:83], v[192:207]
s_waitcnt vmcnt(12)
ds_read_b64_tr_b16 v[96:97], v185 offset:40960
ds_read_b64_tr_b16 v[98:99], v185 offset:41216
ds_read_b64_tr_b16 v[100:101], v185 offset:16384
ds_read_b64_tr_b16 v[102:103], v185 offset:16640
v_mfma_f32_32x32x16_bf16 v[208:223], v[236:239], v[84:87], v[208:223]
ds_read_b128 v[224:227], v248 offset:384
ds_read_b128 v[228:231], v248 offset:17024
s_barrier
s_waitcnt lgkmcnt(7)
v_mfma_f32_32x32x16_bf16 v[128:143], v[240:243], v[88:91], v[128:143]
s_waitcnt lgkmcnt(2)
s_add_u32 m0, s40, 54080
s_mov_b32 s44, 16384
buffer_load_dwordx4 v191, s[24:27], s44 offen lds
v_mfma_f32_32x32x16_bf16 v[144:159], v[240:243], v[92:95], v[144:159]
s_add_u32 m0, s40, 58240
s_mov_b32 s42, 32768
buffer_load_dwordx4 v191, s[24:27], s42 offen lds
v_mfma_f32_32x32x16_bf16 v[192:207], v[244:247], v[88:91], v[192:207]
s_waitcnt vmcnt(12)
ds_read_b64_tr_b16 v[104:105], v185 offset:24576
ds_read_b64_tr_b16 v[106:107], v185 offset:24832
ds_read_b64_tr_b16 v[108:109], v185
ds_read_b64_tr_b16 v[110:111], v185 offset:256
v_mfma_f32_32x32x16_bf16 v[208:223], v[244:247], v[92:95], v[208:223]
ds_read_b128 v[232:235], v248 offset:416
ds_read_b128 v[236:239], v248 offset:17056
s_waitcnt lgkmcnt(7)
v_mfma_f32_32x32x16_bf16 v[128:143], v[224:227], v[96:99], v[128:143]
s_waitcnt lgkmcnt(2)
s_add_u32 m0, s40, 62400
s_mov_b32 s43, 49152
buffer_load_dwordx4 v191, s[24:27], s43 offen lds
v_mfma_f32_32x32x16_bf16 v[144:159], v[224:227], v[100:103], v[144:159]
v_mfma_f32_32x32x16_bf16 v[192:207], v[228:231], v[96:99], v[192:207]
s_waitcnt vmcnt(11)
ds_read_b64_tr_b16 v[112:113], v185 offset:8192
ds_read_b64_tr_b16 v[114:115], v185 offset:8448
ds_read_b64_tr_b16 v[116:117], v160
ds_read_b64_tr_b16 v[118:119], v160 offset:256
v_mfma_f32_32x32x16_bf16 v[208:223], v[228:231], v[100:103], v[208:223]
ds_read_b128 v[240:243], v248 offset:448
ds_read_b128 v[244:247], v248 offset:17088
s_waitcnt lgkmcnt(7)
v_mfma_f32_32x32x16_bf16 v[128:143], v[232:235], v[104:107], v[128:143]
s_waitcnt lgkmcnt(2)
v_mfma_f32_32x32x16_bf16 v[144:159], v[232:235], v[108:111], v[144:159]
v_mfma_f32_32x32x16_bf16 v[192:207], v[236:239], v[104:107], v[192:207]
s_waitcnt vmcnt(9)
ds_read_b64_tr_b16 v[120:121], v160 offset:1024
ds_read_b64_tr_b16 v[122:123], v160 offset:1280
ds_read_b64_tr_b16 v[124:125], v160 offset:2048
ds_read_b64_tr_b16 v[126:127], v160 offset:2304
v_mfma_f32_32x32x16_bf16 v[208:223], v[236:239], v[108:111], v[208:223]
ds_read_b128 v[224:227], v248 offset:480
ds_read_b128 v[228:231], v248 offset:17120
s_waitcnt lgkmcnt(7)
v_mfma_f32_32x32x16_bf16 v[128:143], v[240:243], v[112:115], v[128:143]
s_waitcnt lgkmcnt(2)
v_mfma_f32_32x32x16_bf16 v[144:159], v[240:243], v[116:119], v[144:159]
v_mfma_f32_32x32x16_bf16 v[192:207], v[244:247], v[112:115], v[192:207]
v_mfma_f32_32x32x16_bf16 v[208:223], v[244:247], v[116:119], v[208:223]
s_waitcnt lgkmcnt(1)
v_mfma_f32_32x32x16_bf16 v[128:143], v[224:227], v[120:123], v[128:143]
v_mfma_f32_32x32x16_bf16 v[144:159], v[224:227], v[124:127], v[144:159]
s_waitcnt lgkmcnt(0)
v_mfma_f32_32x32x16_bf16 v[192:207], v[228:231], v[120:123], v[192:207]
v_mfma_f32_32x32x16_bf16 v[208:223], v[228:231], v[124:127], v[208:223]
s_setprio 2
ds_read2_b32 v[224:225], v253 offset0:0 offset1:2
ds_read2_b32 v[226:227], v253 offset0:4 offset1:6
ds_read2_b32 v[228:229], v253 offset0:8 offset1:10
ds_read2_b32 v[230:231], v253 offset0:12 offset1:14
ds_read2_b32 v[232:233], v253 offset0:16 offset1:18
ds_read2_b32 v[234:235], v253 offset0:20 offset1:22
ds_read2_b32 v[236:237], v253 offset0:24 offset1:26
ds_read2_b32 v[238:239], v253 offset0:28 offset1:30
ds_read2_b32 v[240:241], v253 offset0:32 offset1:34
ds_read2_b32 v[242:243], v253 offset0:36 offset1:38
v_mul_f32 v152, s37, v152
v_mul_f32 v153, s37, v153
v_mul_f32 v154, s37, v154
v_mul_f32 v155, s37, v155
v_exp_f32 v152, v152
v_exp_f32 v153, v153
v_exp_f32 v154, v154
v_exp_f32 v155, v155
v_fma_f32 v152, v152, s38, s38
v_fma_f32 v153, v153, s38, s38
v_fma_f32 v154, v154, s38, s38
v_fma_f32 v155, v155, s38, s38
v_rcp_f32 v152, v152
v_rcp_f32 v153, v153
v_rcp_f32 v154, v154
v_rcp_f32 v155, v155
v_mul_f32 v136, v136, v152
v_mul_f32 v137, v137, v153
v_mul_f32 v138, v138, v154
v_mul_f32 v139, v139, v155
v_cvt_pk_bf16_f32 v128, v136, v137
v_cvt_pk_bf16_f32 v129, v138, v139
v_mul_f32 v156, s37, v156
v_mul_f32 v157, s37, v157
v_mul_f32 v158, s37, v158
v_mul_f32 v159, s37, v159
v_exp_f32 v156, v156
v_exp_f32 v157, v157
v_exp_f32 v158, v158
v_exp_f32 v159, v159
v_fma_f32 v156, v156, s38, s38
v_fma_f32 v157, v157, s38, s38
v_fma_f32 v158, v158, s38, s38
v_fma_f32 v159, v159, s38, s38
v_rcp_f32 v156, v156
v_rcp_f32 v157, v157
v_rcp_f32 v158, v158
v_rcp_f32 v159, v159
v_mul_f32 v140, v140, v156
v_mul_f32 v141, v141, v157
v_mul_f32 v142, v142, v158
v_mul_f32 v143, v143, v159
v_cvt_pk_bf16_f32 v130, v140, v141
v_cvt_pk_bf16_f32 v131, v142, v143
v_mul_f32 v208, s37, v208
v_mul_f32 v209, s37, v209
v_mul_f32 v210, s37, v210
v_mul_f32 v211, s37, v211
v_exp_f32 v208, v208
v_exp_f32 v209, v209
v_exp_f32 v210, v210
v_exp_f32 v211, v211
v_fma_f32 v208, v208, s38, s38
v_fma_f32 v209, v209, s38, s38
v_fma_f32 v210, v210, s38, s38
v_fma_f32 v211, v211, s38, s38
v_rcp_f32 v208, v208
v_rcp_f32 v209, v209
v_rcp_f32 v210, v210
v_rcp_f32 v211, v211
v_mul_f32 v192, v192, v208
v_mul_f32 v193, v193, v209
v_mul_f32 v194, v194, v210
v_mul_f32 v195, v195, v211
v_cvt_pk_bf16_f32 v208, v192, v193
v_cvt_pk_bf16_f32 v209, v194, v195
v_mul_f32 v212, s37, v212
v_mul_f32 v213, s37, v213
v_mul_f32 v214, s37, v214
v_mul_f32 v215, s37, v215
v_exp_f32 v212, v212
v_exp_f32 v213, v213
v_exp_f32 v214, v214
v_exp_f32 v215, v215
v_fma_f32 v212, v212, s38, s38
v_fma_f32 v213, v213, s38, s38
v_fma_f32 v214, v214, s38, s38
v_fma_f32 v215, v215, s38, s38
v_rcp_f32 v212, v212
v_rcp_f32 v213, v213
v_rcp_f32 v214, v214
v_rcp_f32 v215, v215
v_mul_f32 v196, v196, v212
v_mul_f32 v197, v197, v213
v_mul_f32 v198, v198, v214
v_mul_f32 v199, v199, v215
v_cvt_pk_bf16_f32 v210, v196, v197
v_cvt_pk_bf16_f32 v211, v198, v199
v_mul_f32 v216, s37, v216
v_mul_f32 v217, s37, v217
v_mul_f32 v218, s37, v218
v_mul_f32 v219, s37, v219
v_exp_f32 v216, v216
v_exp_f32 v217, v217
v_exp_f32 v218, v218
v_exp_f32 v219, v219
v_fma_f32 v216, v216, s38, s38
v_fma_f32 v217, v217, s38, s38
v_fma_f32 v218, v218, s38, s38
v_fma_f32 v219, v219, s38, s38
v_rcp_f32 v216, v216
v_rcp_f32 v217, v217
v_rcp_f32 v218, v218
v_rcp_f32 v219, v219
v_mul_f32 v200, v200, v216
v_mul_f32 v201, v201, v217
v_mul_f32 v202, v202, v218
v_mul_f32 v203, v203, v219
v_cvt_pk_bf16_f32 v244, v200, v201
v_cvt_pk_bf16_f32 v245, v202, v203
v_mul_f32 v220, s37, v220
v_mul_f32 v221, s37, v221
v_mul_f32 v222, s37, v222
v_mul_f32 v223, s37, v223
v_exp_f32 v220, v220
v_exp_f32 v221, v221
v_exp_f32 v222, v222
v_exp_f32 v223, v223
v_fma_f32 v220, v220, s38, s38
v_fma_f32 v221, v221, s38, s38
v_fma_f32 v222, v222, s38, s38
v_fma_f32 v223, v223, s38, s38
v_rcp_f32 v220, v220
v_rcp_f32 v221, v221
v_rcp_f32 v222, v222
v_rcp_f32 v223, v223
v_mul_f32 v204, v204, v220
v_mul_f32 v205, v205, v221
v_mul_f32 v206, v206, v222
v_mul_f32 v207, v207, v223
v_cvt_pk_bf16_f32 v246, v204, v205
v_cvt_pk_bf16_f32 v247, v206, v207
ds_write_b128 v249, v[128:131]
ds_write_b128 v249, v[208:211] offset:32
ds_write_b128 v249, v[244:247] offset:64
ds_read_b128 v[192:195], v250
ds_read_b128 v[212:215], v250 offset:1536
ds_read_b128 v[196:199], v250 offset:16
ds_read_b128 v[216:219], v250 offset:1552
ds_read_b128 v[200:203], v250 offset:32
ds_read_b128 v[220:223], v250 offset:1568
ds_write_b128 v249, v[244:247]
s_waitcnt vmcnt(4)
s_barrier
s_mov_b32 m0, s41
s_mov_b32 s44, 65536
buffer_load_dwordx4 v191, s[24:27], s44 offen lds
s_add_u32 m0, s41, 8192
s_mov_b32 s42, 81920
buffer_load_dwordx4 v191, s[24:27], s42 offen lds
s_add_u32 m0, s41, 32768
s_mov_b32 s43, 98304
buffer_load_dwordx4 v191, s[24:27], s43 offen lds
s_add_u32 m0, s41, 40960
s_mov_b32 s44, 114688
buffer_load_dwordx4 v191, s[24:27], s44 offen lds
s_waitcnt lgkmcnt(1)
s_setprio 3
v_mfma_f32_4x4x4_16b_bf16 v[204:207], v[224:225], v[192:193], 0
v_mfma_f32_4x4x4_16b_bf16 v[208:211], v[224:225], v[194:195], 0
v_mfma_f32_4x4x4_16b_bf16 v[244:247], v[234:235], v[212:213], 0
v_mfma_f32_4x4x4_16b_bf16 v[204:207], v[226:227], v[194:195], v[204:207]
v_mfma_f32_4x4x4_16b_bf16 v[208:211], v[226:227], v[196:197], v[208:211]
v_mfma_f32_4x4x4_16b_bf16 v[224:227], v[234:235], v[214:215], 0
v_mfma_f32_4x4x4_16b_bf16 v[244:247], v[236:237], v[214:215], v[244:247]
v_mfma_f32_4x4x4_16b_bf16 v[204:207], v[228:229], v[196:197], v[204:207]
v_mfma_f32_4x4x4_16b_bf16 v[224:227], v[236:237], v[216:217], v[224:227]
v_mfma_f32_4x4x4_16b_bf16 v[208:211], v[228:229], v[198:199], v[208:211]
v_mfma_f32_4x4x4_16b_bf16 v[244:247], v[238:239], v[216:217], v[244:247]
v_mfma_f32_4x4x4_16b_bf16 v[204:207], v[230:231], v[198:199], v[204:207]
v_mfma_f32_4x4x4_16b_bf16 v[224:227], v[238:239], v[218:219], v[224:227]
v_mfma_f32_4x4x4_16b_bf16 v[208:211], v[230:231], v[200:201], v[208:211]
v_mfma_f32_4x4x4_16b_bf16 v[244:247], v[240:241], v[218:219], v[244:247]
v_mfma_f32_4x4x4_16b_bf16 v[224:227], v[240:241], v[220:221], v[224:227]
v_mfma_f32_4x4x4_16b_bf16 v[204:207], v[232:233], v[200:201], v[204:207]
v_mfma_f32_4x4x4_16b_bf16 v[208:211], v[232:233], v[202:203], v[208:211]
v_mfma_f32_4x4x4_16b_bf16 v[244:247], v[242:243], v[220:221], v[244:247]
v_mfma_f32_4x4x4_16b_bf16 v[224:227], v[242:243], v[222:223], v[224:227]
s_setprio 2
s_add_u32 m0, s41, 16384
s_mov_b32 s42, 8192
buffer_load_dwordx4 v191, s[24:27], s42 offen lds
v_exp_f32 v192, v204
v_exp_f32 v193, v205
v_exp_f32 v194, v206
v_exp_f32 v195, v207
s_waitcnt vmcnt(8)
ds_read_b64_tr_b16 v[128:129], v190 offset:49920
ds_read_b64_tr_b16 v[130:131], v190 offset:50176
v_fma_f32 v192, v192, s37, s37
v_fma_f32 v193, v193, s37, s37
s_add_u32 m0, s41, 24576
s_mov_b32 s43, 24576
buffer_load_dwordx4 v191, s[24:27], s43 offen lds
v_fma_f32 v194, v194, s37, s37
v_fma_f32 v195, v195, s37, s37
v_rcp_f32 v192, v192
s_waitcnt vmcnt(8)
ds_read_b64_tr_b16 v[132:133], v190 offset:54080
ds_read_b64_tr_b16 v[134:135], v190 offset:54336
v_rcp_f32 v193, v193
v_rcp_f32 v194, v194
v_rcp_f32 v195, v195
s_mov_b32 m0, s40
s_mov_b32 s44, 40960
buffer_load_dwordx4 v191, s[24:27], s44 offen lds
v_mul_f32 v204, v204, v192
v_mul_f32 v205, v205, v193
s_waitcnt vmcnt(8)
ds_read_b64_tr_b16 v[136:137], v190 offset:58240
ds_read_b64_tr_b16 v[138:139], v190 offset:58496
v_mul_f32 v206, v206, v194
v_mul_f32 v207, v207, v195
v_cvt_pk_bf16_f32 v204, v204, v205
v_cvt_pk_bf16_f32 v205, v206, v207
s_add_u32 m0, s40, 4160
s_mov_b32 s42, 57344
buffer_load_dwordx4 v191, s[24:27], s42 offen lds
v_exp_f32 v196, v208
s_waitcnt vmcnt(8)
ds_read_b64_tr_b16 v[140:141], v190 offset:62400
ds_read_b64_tr_b16 v[142:143], v190 offset:62656
v_exp_f32 v197, v209
v_exp_f32 v198, v210
v_exp_f32 v199, v211
v_fma_f32 v196, v196, s37, s37
v_fma_f32 v197, v197, s37, s37
s_add_u32 m0, s40, 8320
s_mov_b32 s43, 73728
buffer_load_dwordx4 v191, s[24:27], s43 offen lds
s_waitcnt vmcnt(8)
ds_read_b64_tr_b16 v[144:145], v189
ds_read_b64_tr_b16 v[146:147], v189 offset:256
v_fma_f32 v198, v198, s37, s37
v_fma_f32 v199, v199, s37, s37
v_rcp_f32 v196, v196
v_rcp_f32 v197, v197
v_rcp_f32 v198, v198
s_waitcnt vmcnt(7)
ds_read_b64_tr_b16 v[148:149], v189 offset:8192
ds_read_b64_tr_b16 v[150:151], v189 offset:8448
v_rcp_f32 v199, v199
s_add_u32 m0, s40, 12480
s_mov_b32 s44, 90112
buffer_load_dwordx4 v191, s[24:27], s44 offen lds
v_mul_f32 v208, v208, v196
v_mul_f32 v209, v209, v197
v_mul_f32 v210, v210, v198
v_mul_f32 v211, v211, v199
s_waitcnt vmcnt(7)
ds_read_b64_tr_b16 v[152:153], v189 offset:32768
ds_read_b64_tr_b16 v[154:155], v189 offset:33024
v_cvt_pk_bf16_f32 v206, v208, v209
v_cvt_pk_bf16_f32 v207, v210, v211
s_waitcnt vmcnt(6)
ds_read_b64_tr_b16 v[156:157], v189 offset:40960
ds_read_b64_tr_b16 v[158:159], v189 offset:41216
s_waitcnt vmcnt(5)
ds_read_b64_tr_b16 v[160:161], v189 offset:16384
ds_read_b64_tr_b16 v[162:163], v189 offset:16640
s_waitcnt lgkmcnt(0)
s_add_u32 m0, s41, 16384
s_mov_b32 s42, 106496
buffer_load_dwordx4 v191, s[24:27], s42 offen lds
v_exp_f32 v192, v244
v_exp_f32 v193, v245
s_waitcnt vmcnt(5)
ds_read_b64_tr_b16 v[164:165], v189 offset:24576
ds_read_b64_tr_b16 v[166:167], v189 offset:24832
v_exp_f32 v194, v246
v_exp_f32 v195, v247
v_fma_f32 v192, v192, s37, s37
s_waitcnt lgkmcnt(0)
s_add_u32 m0, s41, 24576
s_mov_b32 s43, 122880
buffer_load_dwordx4 v191, s[24:27], s43 offen lds
v_fma_f32 v193, v193, s37, s37
v_fma_f32 v194, v194, s37, s37
s_waitcnt vmcnt(5)
ds_read_b64_tr_b16 v[168:169], v190
ds_read_b64_tr_b16 v[170:171], v190 offset:256
v_fma_f32 v195, v195, s37, s37
v_rcp_f32 v192, v192
v_rcp_f32 v193, v193
v_rcp_f32 v194, v194
v_rcp_f32 v195, v195
s_waitcnt vmcnt(4)
ds_read_b64_tr_b16 v[172:173], v190 offset:4160
ds_read_b64_tr_b16 v[174:175], v190 offset:4416
v_mul_f32 v244, v244, v192
v_mul_f32 v245, v245, v193
v_mul_f32 v246, v246, v194
v_mul_f32 v247, v247, v195
v_cvt_pk_bf16_f32 v244, v244, v245
v_cvt_pk_bf16_f32 v245, v246, v247
v_exp_f32 v196, v224
v_exp_f32 v197, v225
v_exp_f32 v198, v226
v_exp_f32 v199, v227
v_fma_f32 v196, v196, s37, s37
v_fma_f32 v197, v197, s37, s37
v_fma_f32 v198, v198, s37, s37
v_fma_f32 v199, v199, s37, s37
v_rcp_f32 v196, v196
v_rcp_f32 v197, v197
v_rcp_f32 v198, v198
v_rcp_f32 v199, v199
v_mul_f32 v224, v224, v196
v_mul_f32 v225, v225, v197
v_mul_f32 v226, v226, v198
v_mul_f32 v227, v227, v199
v_cvt_pk_bf16_f32 v246, v224, v225
v_cvt_pk_bf16_f32 v247, v226, v227
ds_write_b128 v251, v[204:207]
ds_write_b128 v251, v[244:247] offset:8192
s_waitcnt lgkmcnt(0)
s_barrier
s_setprio 2
ds_read_b64_tr_b16 v[200:201], v252
ds_read_b64_tr_b16 v[202:203], v252 offset:256
ds_read_b64_tr_b16 v[212:213], v252 offset:1024
ds_read_b64_tr_b16 v[214:215], v252 offset:1280
ds_read_b64_tr_b16 v[216:217], v252 offset:2048
ds_read_b64_tr_b16 v[218:219], v252 offset:2304
ds_read_b64_tr_b16 v[220:221], v252 offset:3072
ds_read_b64_tr_b16 v[222:223], v252 offset:3328
ds_read_b64_tr_b16 v[204:205], v252 offset:4096
ds_read_b64_tr_b16 v[206:207], v252 offset:4352
ds_read_b64_tr_b16 v[208:209], v252 offset:5120
ds_read_b64_tr_b16 v[210:211], v252 offset:5376
s_waitcnt lgkmcnt(10)
v_mfma_f32_32x32x16_bf16 v[224:239], v[128:131], v[200:203], 0
ds_read_b64_tr_b16 v[192:193], v252 offset:6144
ds_read_b64_tr_b16 v[194:195], v252 offset:6400
s_add_u32 m0, s41, 32768
s_mov_b32 s44, 106240
buffer_load_dwordx4 v191, s[24:27], s44 offen lds
s_waitcnt lgkmcnt(10)
v_mfma_f32_32x32x16_bf16 v[224:239], v[132:135], v[212:215], v[224:239]
ds_read_b64_tr_b16 v[196:197], v252 offset:7168
ds_read_b64_tr_b16 v[198:199], v252 offset:7424
s_add_u32 m0, s41, 40960
s_mov_b32 s42, 122624
buffer_load_dwordx4 v191, s[24:27], s42 offen lds
s_waitcnt lgkmcnt(10)
v_mfma_f32_32x32x16_bf16 v[224:239], v[136:139], v[216:219], v[224:239]
ds_read_b64_tr_b16 v[200:201], v252 offset:8192
ds_read_b64_tr_b16 v[202:203], v252 offset:8448
s_waitcnt lgkmcnt(10)
v_mfma_f32_32x32x16_bf16 v[224:239], v[140:143], v[220:223], v[224:239]
ds_read_b64_tr_b16 v[212:213], v252 offset:9216
ds_read_b64_tr_b16 v[214:215], v252 offset:9472
s_waitcnt lgkmcnt(10)
v_mfma_f32_32x32x16_bf16 v[224:239], v[144:147], v[204:207], v[224:239]
ds_read_b64_tr_b16 v[216:217], v252 offset:10240
ds_read_b64_tr_b16 v[218:219], v252 offset:10496
s_waitcnt lgkmcnt(10)
v_mfma_f32_32x32x16_bf16 v[224:239], v[148:151], v[208:211], v[224:239]
ds_read_b64_tr_b16 v[220:221], v252 offset:11264
ds_read_b64_tr_b16 v[222:223], v252 offset:11520
s_waitcnt lgkmcnt(10)
v_mfma_f32_32x32x16_bf16 v[224:239], v[152:155], v[192:195], v[224:239]
ds_read_b64_tr_b16 v[204:205], v252 offset:12288
ds_read_b64_tr_b16 v[206:207], v252 offset:12544
s_waitcnt lgkmcnt(10)
v_mfma_f32_32x32x16_bf16 v[224:239], v[156:159], v[196:199], v[224:239]
ds_read_b64_tr_b16 v[208:209], v252 offset:13312
ds_read_b64_tr_b16 v[210:211], v252 offset:13568
s_waitcnt lgkmcnt(10)
v_mfma_f32_32x32x16_bf16 v[224:239], v[160:163], v[200:203], v[224:239]
ds_read_b64_tr_b16 v[192:193], v252 offset:14336
ds_read_b64_tr_b16 v[194:195], v252 offset:14592
s_waitcnt vmcnt(5)
ds_read_b64_tr_b16 v[176:177], v190 offset:8320
ds_read_b64_tr_b16 v[178:179], v190 offset:8576
s_waitcnt lgkmcnt(12)
v_mfma_f32_32x32x16_bf16 v[224:239], v[164:167], v[212:215], v[224:239]
ds_read_b64_tr_b16 v[196:197], v252 offset:15360
ds_read_b64_tr_b16 v[198:199], v252 offset:15616
s_waitcnt vmcnt(4)
ds_read_b64_tr_b16 v[180:181], v190 offset:12480
ds_read_b64_tr_b16 v[182:183], v190 offset:12736
s_waitcnt lgkmcnt(14)
v_mfma_f32_32x32x16_bf16 v[224:239], v[168:171], v[216:219], v[224:239]
s_waitcnt vmcnt(3)
ds_read_b64_tr_b16 v[184:185], v189 offset:16384
ds_read_b64_tr_b16 v[186:187], v189 offset:16640
s_add_u32 m0, s40, 49920
s_add_u32 s43, s39, 49152
buffer_load_dwordx4 v255, s[16:19], s43 offen nt lds
s_waitcnt lgkmcnt(14)
v_mfma_f32_32x32x16_bf16 v[224:239], v[172:175], v[220:223], v[224:239]
s_waitcnt vmcnt(3)
ds_read_b64_tr_b16 v[190:191], v189 offset:24832
ds_read_b64_tr_b16 v[188:189], v189 offset:24576
s_add_u32 m0, s40, 54080
s_add_u32 s44, s39, 53248
buffer_load_dwordx4 v255, s[16:19], s44 offen nt lds
s_waitcnt lgkmcnt(8)
v_mfma_f32_32x32x16_bf16 v[224:239], v[176:179], v[204:207], v[224:239]
s_add_u32 m0, s40, 58240
s_add_u32 s42, s39, 51200
buffer_load_dwordx4 v255, s[16:19], s42 offen nt lds
ds_read_b128 v[240:243], v248 offset:33280
s_waitcnt lgkmcnt(5)
v_mfma_f32_32x32x16_bf16 v[224:239], v[180:183], v[208:211], v[224:239]
s_add_u32 m0, s40, 62400
s_add_u32 s43, s39, 55296
buffer_load_dwordx4 v255, s[16:19], s43 offen nt lds
ds_read_b128 v[244:247], v248 offset:33312
s_waitcnt lgkmcnt(4)
v_mfma_f32_32x32x16_bf16 v[224:239], v[184:187], v[192:195], v[224:239]
s_waitcnt lgkmcnt(2)
v_mfma_f32_32x32x16_bf16 v[224:239], v[188:191], v[196:199], v[224:239]
s_waitcnt lgkmcnt(1)
v_mfma_f32_32x32x16_bf16 v[192:207], v[240:243], v[0:3], 0
v_mfma_f32_32x32x16_bf16 v[208:223], v[240:243], v[4:7], 0
ds_read_b128 v[240:243], v248 offset:33344
s_waitcnt lgkmcnt(1)
v_mfma_f32_32x32x16_bf16 v[192:207], v[244:247], v[8:11], v[192:207]
v_mfma_f32_32x32x16_bf16 v[208:223], v[244:247], v[12:15], v[208:223]
ds_read_b128 v[244:247], v248 offset:33376
s_nop 3
v_cvt_pk_bf16_f32 v224, v224, v225
v_cvt_pk_bf16_f32 v225, v226, v227
v_cvt_pk_bf16_f32 v226, v228, v229
v_cvt_pk_bf16_f32 v227, v230, v231
s_waitcnt lgkmcnt(1)
v_mfma_f32_32x32x16_bf16 v[192:207], v[240:243], v[16:19], v[192:207]
v_mfma_f32_32x32x16_bf16 v[208:223], v[240:243], v[20:23], v[208:223]
ds_read_b128 v[240:243], v248 offset:33408
v_cvt_pk_bf16_f32 v228, v232, v233
v_cvt_pk_bf16_f32 v229, v234, v235
v_cvt_pk_bf16_f32 v230, v236, v237
v_cvt_pk_bf16_f32 v231, v238, v239
v_permlane16_swap_b32 v224, v228
v_permlane16_swap_b32 v225, v229
v_permlane16_swap_b32 v226, v230
v_permlane16_swap_b32 v227, v231
buffer_store_dwordx4 v[224:227], v254, s[32:35], 0 offen sc0 sc1 nt
s_mov_b32 s44, 8192
buffer_store_dwordx4 v[228:231], v254, s[32:35], s44 offen sc0 sc1 nt
ds_read_b128 v[232:235], v248 offset:33440
ds_read_b128 v[236:239], v248 offset:33472
s_waitcnt lgkmcnt(3)
v_mfma_f32_32x32x16_bf16 v[192:207], v[244:247], v[24:27], v[192:207]
v_mfma_f32_32x32x16_bf16 v[208:223], v[244:247], v[28:31], v[208:223]
ds_read_b128 v[244:247], v248 offset:33504
s_waitcnt lgkmcnt(3)
v_mfma_f32_32x32x16_bf16 v[192:207], v[240:243], v[32:35], v[192:207]
v_mfma_f32_32x32x16_bf16 v[208:223], v[240:243], v[36:39], v[208:223]
ds_read_b128 v[240:243], v248 offset:33536
s_waitcnt lgkmcnt(3)
v_mfma_f32_32x32x16_bf16 v[192:207], v[232:235], v[40:43], v[192:207]
v_mfma_f32_32x32x16_bf16 v[208:223], v[232:235], v[44:47], v[208:223]
ds_read_b128 v[232:235], v248 offset:33568
s_waitcnt lgkmcnt(3)
v_mfma_f32_32x32x16_bf16 v[192:207], v[236:239], v[48:51], v[192:207]
v_mfma_f32_32x32x16_bf16 v[208:223], v[236:239], v[52:55], v[208:223]
ds_read_b128 v[236:239], v248 offset:33600
s_waitcnt lgkmcnt(3)
v_mfma_f32_32x32x16_bf16 v[192:207], v[244:247], v[56:59], v[192:207]
v_mfma_f32_32x32x16_bf16 v[208:223], v[244:247], v[60:63], v[208:223]
ds_read_b128 v[244:247], v248 offset:33632
s_waitcnt lgkmcnt(3)
v_mfma_f32_32x32x16_bf16 v[192:207], v[240:243], v[64:67], v[192:207]
v_mfma_f32_32x32x16_bf16 v[208:223], v[240:243], v[68:71], v[208:223]
ds_read_b128 v[240:243], v248 offset:33664
s_waitcnt lgkmcnt(3)
v_mfma_f32_32x32x16_bf16 v[192:207], v[232:235], v[72:75], v[192:207]
v_mfma_f32_32x32x16_bf16 v[208:223], v[232:235], v[76:79], v[208:223]
ds_read_b128 v[232:235], v248 offset:33696
s_waitcnt lgkmcnt(3)
v_mfma_f32_32x32x16_bf16 v[192:207], v[236:239], v[80:83], v[192:207]
v_mfma_f32_32x32x16_bf16 v[208:223], v[236:239], v[84:87], v[208:223]
ds_read_b128 v[236:239], v248 offset:33728
s_waitcnt lgkmcnt(3)
v_mfma_f32_32x32x16_bf16 v[192:207], v[244:247], v[88:91], v[192:207]
v_mfma_f32_32x32x16_bf16 v[208:223], v[244:247], v[92:95], v[208:223]
ds_read_b128 v[244:247], v248 offset:33760
s_waitcnt lgkmcnt(3)
v_mfma_f32_32x32x16_bf16 v[192:207], v[240:243], v[96:99], v[192:207]
v_mfma_f32_32x32x16_bf16 v[208:223], v[240:243], v[100:103], v[208:223]
ds_read2_b32 v[224:225], v253 offset0:0 offset1:2
ds_read2_b32 v[226:227], v253 offset0:4 offset1:6
ds_read2_b32 v[228:229], v253 offset0:8 offset1:10
ds_read2_b32 v[230:231], v253 offset0:12 offset1:14
s_waitcnt lgkmcnt(6)
v_mfma_f32_32x32x16_bf16 v[192:207], v[232:235], v[104:107], v[192:207]
v_mfma_f32_32x32x16_bf16 v[208:223], v[232:235], v[108:111], v[208:223]
ds_read2_b32 v[232:233], v253 offset0:16 offset1:18
ds_read2_b32 v[234:235], v253 offset0:20 offset1:22
s_waitcnt lgkmcnt(7)
v_mfma_f32_32x32x16_bf16 v[192:207], v[236:239], v[112:115], v[192:207]
v_mfma_f32_32x32x16_bf16 v[208:223], v[236:239], v[116:119], v[208:223]
ds_read2_b32 v[236:237], v253 offset0:24 offset1:26
ds_read2_b32 v[238:239], v253 offset0:28 offset1:30
s_waitcnt lgkmcnt(8)
v_mfma_f32_32x32x16_bf16 v[192:207], v[244:247], v[120:123], v[192:207]
v_mfma_f32_32x32x16_bf16 v[208:223], v[244:247], v[124:127], v[208:223]
ds_read2_b32 v[240:241], v253 offset0:32 offset1:34
ds_read2_b32 v[242:243], v253 offset0:36 offset1:38
s_setprio 0
s_mov_b32 m0, s40
s_add_u32 s42, s39, 65536
buffer_load_dwordx4 v255, s[16:19], s42 offen nt lds
s_add_u32 m0, s40, 4160
s_add_u32 s43, s39, 69632
buffer_load_dwordx4 v255, s[16:19], s43 offen nt lds
s_nop 2
v_mul_f32 v208, s37, v208
s_add_u32 m0, s40, 8320
s_add_u32 s44, s39, 67584
buffer_load_dwordx4 v255, s[16:19], s44 offen nt lds
v_mul_f32 v209, s37, v209
s_add_u32 m0, s40, 12480
s_add_u32 s42, s39, 71680
buffer_load_dwordx4 v255, s[16:19], s42 offen nt lds
v_mul_f32 v210, s37, v210
v_mul_f32 v211, s37, v211
v_exp_f32 v208, v208
v_exp_f32 v209, v209
v_exp_f32 v210, v210
v_exp_f32 v211, v211
v_fma_f32 v208, v208, s38, s38
v_fma_f32 v209, v209, s38, s38
v_fma_f32 v210, v210, s38, s38
v_fma_f32 v211, v211, s38, s38
v_rcp_f32 v208, v208
v_rcp_f32 v209, v209
v_rcp_f32 v210, v210
v_rcp_f32 v211, v211
v_mul_f32 v192, v192, v208
v_mul_f32 v193, v193, v209
v_mul_f32 v194, v194, v210
v_mul_f32 v195, v195, v211
v_cvt_pk_bf16_f32 v208, v192, v193
v_cvt_pk_bf16_f32 v209, v194, v195
v_mul_f32 v212, s37, v212
v_mul_f32 v213, s37, v213
v_mul_f32 v214, s37, v214
v_mul_f32 v215, s37, v215
v_exp_f32 v212, v212
v_exp_f32 v213, v213
v_exp_f32 v214, v214
v_exp_f32 v215, v215
v_fma_f32 v212, v212, s38, s38
v_fma_f32 v213, v213, s38, s38
v_fma_f32 v214, v214, s38, s38
v_fma_f32 v215, v215, s38, s38
v_rcp_f32 v212, v212
v_rcp_f32 v213, v213
v_rcp_f32 v214, v214
v_rcp_f32 v215, v215
v_mul_f32 v196, v196, v212
v_mul_f32 v197, v197, v213
v_mul_f32 v198, v198, v214
v_mul_f32 v199, v199, v215
v_cvt_pk_bf16_f32 v210, v196, v197
v_cvt_pk_bf16_f32 v211, v198, v199
ds_write_b128 v249, v[208:211] offset:32
ds_read_b128 v[192:195], v250
ds_read_b128 v[212:215], v250 offset:1536
v_mul_f32 v216, s37, v216
v_mul_f32 v217, s37, v217
v_mul_f32 v218, s37, v218
v_mul_f32 v219, s37, v219
s_waitcnt vmcnt(6)
s_barrier
v_exp_f32 v216, v216
v_exp_f32 v217, v217
v_exp_f32 v218, v218
v_exp_f32 v219, v219
v_fma_f32 v216, v216, s38, s38
v_fma_f32 v217, v217, s38, s38
v_fma_f32 v218, v218, s38, s38
v_fma_f32 v219, v219, s38, s38
v_rcp_f32 v216, v216
v_rcp_f32 v217, v217
v_rcp_f32 v218, v218
v_rcp_f32 v219, v219
v_mul_f32 v200, v200, v216
v_mul_f32 v201, v201, v217
v_mul_f32 v202, v202, v218
v_mul_f32 v203, v203, v219
v_cvt_pk_bf16_f32 v244, v200, v201
v_cvt_pk_bf16_f32 v245, v202, v203
v_mul_f32 v220, s37, v220
v_mul_f32 v221, s37, v221
v_mul_f32 v222, s37, v222
v_mul_f32 v223, s37, v223
v_exp_f32 v220, v220
v_exp_f32 v221, v221
v_exp_f32 v222, v222
v_exp_f32 v223, v223
v_fma_f32 v220, v220, s38, s38
v_fma_f32 v221, v221, s38, s38
v_fma_f32 v222, v222, s38, s38
v_fma_f32 v223, v223, s38, s38
v_rcp_f32 v220, v220
v_rcp_f32 v221, v221
v_rcp_f32 v222, v222
v_rcp_f32 v223, v223
v_mul_f32 v204, v204, v220
v_mul_f32 v205, v205, v221
v_mul_f32 v206, v206, v222
v_mul_f32 v207, v207, v223
v_cvt_pk_bf16_f32 v246, v204, v205
v_cvt_pk_bf16_f32 v247, v206, v207
ds_write_b128 v249, v[244:247] offset:64
ds_read_b128 v[196:199], v250 offset:16
ds_read_b128 v[216:219], v250 offset:1552
ds_read_b128 v[200:203], v250 offset:32
ds_read_b128 v[220:223], v250 offset:1568
ds_write_b128 v249, v[244:247]
s_waitcnt lgkmcnt(0)
s_setprio 3
v_mfma_f32_4x4x4_16b_bf16 v[204:207], v[224:225], v[192:193], 0
v_mfma_f32_4x4x4_16b_bf16 v[208:211], v[224:225], v[194:195], 0
v_mfma_f32_4x4x4_16b_bf16 v[244:247], v[234:235], v[212:213], 0
v_mfma_f32_4x4x4_16b_bf16 v[204:207], v[226:227], v[194:195], v[204:207]
v_mfma_f32_4x4x4_16b_bf16 v[208:211], v[226:227], v[196:197], v[208:211]
v_mfma_f32_4x4x4_16b_bf16 v[224:227], v[234:235], v[214:215], 0
v_mfma_f32_4x4x4_16b_bf16 v[244:247], v[236:237], v[214:215], v[244:247]
v_mfma_f32_4x4x4_16b_bf16 v[204:207], v[228:229], v[196:197], v[204:207]
v_mfma_f32_4x4x4_16b_bf16 v[224:227], v[236:237], v[216:217], v[224:227]
v_mfma_f32_4x4x4_16b_bf16 v[208:211], v[228:229], v[198:199], v[208:211]
v_mfma_f32_4x4x4_16b_bf16 v[244:247], v[238:239], v[216:217], v[244:247]
v_mfma_f32_4x4x4_16b_bf16 v[204:207], v[230:231], v[198:199], v[204:207]
v_mfma_f32_4x4x4_16b_bf16 v[224:227], v[238:239], v[218:219], v[224:227]
v_mfma_f32_4x4x4_16b_bf16 v[208:211], v[230:231], v[200:201], v[208:211]
v_mfma_f32_4x4x4_16b_bf16 v[244:247], v[240:241], v[218:219], v[244:247]
v_mfma_f32_4x4x4_16b_bf16 v[224:227], v[240:241], v[220:221], v[224:227]
v_mfma_f32_4x4x4_16b_bf16 v[204:207], v[232:233], v[200:201], v[204:207]
v_mfma_f32_4x4x4_16b_bf16 v[208:211], v[232:233], v[202:203], v[208:211]
v_mfma_f32_4x4x4_16b_bf16 v[244:247], v[242:243], v[220:221], v[244:247]
v_mfma_f32_4x4x4_16b_bf16 v[224:227], v[242:243], v[222:223], v[224:227]
s_setprio 0
s_nop 0
v_exp_f32 v192, v204
v_exp_f32 v193, v205
v_exp_f32 v194, v206
v_exp_f32 v195, v207
v_fma_f32 v192, v192, s37, s37
v_fma_f32 v193, v193, s37, s37
v_fma_f32 v194, v194, s37, s37
v_fma_f32 v195, v195, s37, s37
v_rcp_f32 v192, v192
v_rcp_f32 v193, v193
v_rcp_f32 v194, v194
v_rcp_f32 v195, v195
v_mul_f32 v204, v204, v192
v_mul_f32 v205, v205, v193
v_mul_f32 v206, v206, v194
v_mul_f32 v207, v207, v195
v_cvt_pk_bf16_f32 v204, v204, v205
v_cvt_pk_bf16_f32 v205, v206, v207
v_exp_f32 v196, v208
v_exp_f32 v197, v209
v_exp_f32 v198, v210
v_exp_f32 v199, v211
v_fma_f32 v196, v196, s37, s37
v_fma_f32 v197, v197, s37, s37
v_fma_f32 v198, v198, s37, s37
v_fma_f32 v199, v199, s37, s37
v_rcp_f32 v196, v196
v_rcp_f32 v197, v197
v_rcp_f32 v198, v198
v_rcp_f32 v199, v199
v_mul_f32 v208, v208, v196
v_mul_f32 v209, v209, v197
v_mul_f32 v210, v210, v198
v_mul_f32 v211, v211, v199
v_cvt_pk_bf16_f32 v206, v208, v209
v_cvt_pk_bf16_f32 v207, v210, v211
ds_write_b128 v251, v[204:207] offset:16384
v_exp_f32 v192, v244
v_exp_f32 v193, v245
v_exp_f32 v194, v246
v_exp_f32 v195, v247
v_fma_f32 v192, v192, s37, s37
v_fma_f32 v193, v193, s37, s37
v_fma_f32 v194, v194, s37, s37
v_fma_f32 v195, v195, s37, s37
v_rcp_f32 v192, v192
v_rcp_f32 v193, v193
v_rcp_f32 v194, v194
v_rcp_f32 v195, v195
v_mul_f32 v244, v244, v192
v_mul_f32 v245, v245, v193
v_mul_f32 v246, v246, v194
v_mul_f32 v247, v247, v195
v_cvt_pk_bf16_f32 v244, v244, v245
v_cvt_pk_bf16_f32 v245, v246, v247
v_exp_f32 v196, v224
v_exp_f32 v197, v225
v_exp_f32 v198, v226
v_exp_f32 v199, v227
v_fma_f32 v196, v196, s37, s37
v_fma_f32 v197, v197, s37, s37
v_fma_f32 v198, v198, s37, s37
v_fma_f32 v199, v199, s37, s37
v_rcp_f32 v196, v196
v_rcp_f32 v197, v197
v_rcp_f32 v198, v198
v_rcp_f32 v199, v199
v_mul_f32 v224, v224, v196
v_mul_f32 v225, v225, v197
v_mul_f32 v226, v226, v198
v_mul_f32 v227, v227, v199
v_cvt_pk_bf16_f32 v246, v224, v225
v_cvt_pk_bf16_f32 v247, v226, v227
ds_write_b128 v251, v[244:247] offset:24576
s_waitcnt vmcnt(0) lgkmcnt(0)
s_barrier
s_setprio 2
ds_read_b64_tr_b16 v[200:201], v252 offset:16384
ds_read_b64_tr_b16 v[202:203], v252 offset:16640
ds_read_b64_tr_b16 v[212:213], v252 offset:17408
ds_read_b64_tr_b16 v[214:215], v252 offset:17664
ds_read_b64_tr_b16 v[216:217], v252 offset:18432
ds_read_b64_tr_b16 v[218:219], v252 offset:18688
ds_read_b64_tr_b16 v[220:221], v252 offset:19456
ds_read_b64_tr_b16 v[222:223], v252 offset:19712
ds_read_b64_tr_b16 v[204:205], v252 offset:20480
ds_read_b64_tr_b16 v[206:207], v252 offset:20736
ds_read_b64_tr_b16 v[208:209], v252 offset:21504
ds_read_b64_tr_b16 v[210:211], v252 offset:21760
s_waitcnt lgkmcnt(10)
v_mfma_f32_32x32x16_bf16 v[224:239], v[128:131], v[200:203], 0
ds_read_b64_tr_b16 v[192:193], v252 offset:22528
ds_read_b64_tr_b16 v[194:195], v252 offset:22784
s_waitcnt lgkmcnt(10)
v_mfma_f32_32x32x16_bf16 v[224:239], v[132:135], v[212:215], v[224:239]
ds_read_b64_tr_b16 v[196:197], v252 offset:23552
ds_read_b64_tr_b16 v[198:199], v252 offset:23808
s_waitcnt lgkmcnt(10)
v_mfma_f32_32x32x16_bf16 v[224:239], v[136:139], v[216:219], v[224:239]
ds_read_b64_tr_b16 v[200:201], v252 offset:24576
ds_read_b64_tr_b16 v[202:203], v252 offset:24832
s_waitcnt lgkmcnt(10)
v_mfma_f32_32x32x16_bf16 v[224:239], v[140:143], v[220:223], v[224:239]
ds_read_b64_tr_b16 v[212:213], v252 offset:25600
ds_read_b64_tr_b16 v[214:215], v252 offset:25856
s_waitcnt lgkmcnt(10)
v_mfma_f32_32x32x16_bf16 v[224:239], v[144:147], v[204:207], v[224:239]
ds_read_b64_tr_b16 v[216:217], v252 offset:26624
ds_read_b64_tr_b16 v[218:219], v252 offset:26880
s_waitcnt lgkmcnt(10)
v_mfma_f32_32x32x16_bf16 v[224:239], v[148:151], v[208:211], v[224:239]
ds_read_b64_tr_b16 v[220:221], v252 offset:27648
ds_read_b64_tr_b16 v[222:223], v252 offset:27904
s_waitcnt lgkmcnt(10)
v_mfma_f32_32x32x16_bf16 v[224:239], v[152:155], v[192:195], v[224:239]
ds_read_b64_tr_b16 v[204:205], v252 offset:28672
ds_read_b64_tr_b16 v[206:207], v252 offset:28928
s_waitcnt lgkmcnt(10)
v_mfma_f32_32x32x16_bf16 v[224:239], v[156:159], v[196:199], v[224:239]
ds_read_b64_tr_b16 v[208:209], v252 offset:29696
ds_read_b64_tr_b16 v[210:211], v252 offset:29952
s_waitcnt lgkmcnt(10)
v_mfma_f32_32x32x16_bf16 v[224:239], v[160:163], v[200:203], v[224:239]
ds_read_b64_tr_b16 v[192:193], v252 offset:30720
ds_read_b64_tr_b16 v[194:195], v252 offset:30976
s_waitcnt lgkmcnt(10)
v_mfma_f32_32x32x16_bf16 v[224:239], v[164:167], v[212:215], v[224:239]
ds_read_b64_tr_b16 v[196:197], v252 offset:31744
ds_read_b64_tr_b16 v[198:199], v252 offset:32000
s_waitcnt lgkmcnt(10)
v_mfma_f32_32x32x16_bf16 v[224:239], v[168:171], v[216:219], v[224:239]
s_waitcnt lgkmcnt(8)
v_mfma_f32_32x32x16_bf16 v[224:239], v[172:175], v[220:223], v[224:239]
s_waitcnt lgkmcnt(6)
v_mfma_f32_32x32x16_bf16 v[224:239], v[176:179], v[204:207], v[224:239]
ds_read_b128 v[240:243], v248 offset:49920
s_waitcnt lgkmcnt(5)
v_mfma_f32_32x32x16_bf16 v[224:239], v[180:183], v[208:211], v[224:239]
ds_read_b128 v[244:247], v248 offset:49952
s_waitcnt lgkmcnt(4)
v_mfma_f32_32x32x16_bf16 v[224:239], v[184:187], v[192:195], v[224:239]
s_waitcnt lgkmcnt(2)
v_mfma_f32_32x32x16_bf16 v[224:239], v[188:191], v[196:199], v[224:239]
s_waitcnt lgkmcnt(1)
v_mfma_f32_32x32x16_bf16 v[192:207], v[240:243], v[0:3], 0
v_mfma_f32_32x32x16_bf16 v[208:223], v[240:243], v[4:7], 0
ds_read_b128 v[240:243], v248 offset:49984
s_waitcnt lgkmcnt(1)
v_mfma_f32_32x32x16_bf16 v[192:207], v[244:247], v[8:11], v[192:207]
v_mfma_f32_32x32x16_bf16 v[208:223], v[244:247], v[12:15], v[208:223]
ds_read_b128 v[244:247], v248 offset:50016
s_nop 3
v_cvt_pk_bf16_f32 v224, v224, v225
v_cvt_pk_bf16_f32 v225, v226, v227
v_cvt_pk_bf16_f32 v226, v228, v229
v_cvt_pk_bf16_f32 v227, v230, v231
s_waitcnt lgkmcnt(1)
v_mfma_f32_32x32x16_bf16 v[192:207], v[240:243], v[16:19], v[192:207]
v_mfma_f32_32x32x16_bf16 v[208:223], v[240:243], v[20:23], v[208:223]
ds_read_b128 v[240:243], v248 offset:50048
v_cvt_pk_bf16_f32 v228, v232, v233
v_cvt_pk_bf16_f32 v229, v234, v235
v_cvt_pk_bf16_f32 v230, v236, v237
v_cvt_pk_bf16_f32 v231, v238, v239
v_permlane16_swap_b32 v224, v228
v_permlane16_swap_b32 v225, v229
v_permlane16_swap_b32 v226, v230
v_permlane16_swap_b32 v227, v231
s_mov_b32 s43, 16384
buffer_store_dwordx4 v[224:227], v254, s[32:35], s43 offen sc0 sc1 nt
s_mov_b32 s44, 24576
buffer_store_dwordx4 v[228:231], v254, s[32:35], s44 offen sc0 sc1 nt
ds_read_b128 v[232:235], v248 offset:50080
ds_read_b128 v[236:239], v248 offset:50112
s_waitcnt lgkmcnt(3)
v_mfma_f32_32x32x16_bf16 v[192:207], v[244:247], v[24:27], v[192:207]
v_mfma_f32_32x32x16_bf16 v[208:223], v[244:247], v[28:31], v[208:223]
ds_read_b128 v[244:247], v248 offset:50144
s_waitcnt lgkmcnt(3)
v_mfma_f32_32x32x16_bf16 v[192:207], v[240:243], v[32:35], v[192:207]
v_mfma_f32_32x32x16_bf16 v[208:223], v[240:243], v[36:39], v[208:223]
ds_read_b128 v[240:243], v248 offset:50176
s_waitcnt lgkmcnt(3)
v_mfma_f32_32x32x16_bf16 v[192:207], v[232:235], v[40:43], v[192:207]
v_mfma_f32_32x32x16_bf16 v[208:223], v[232:235], v[44:47], v[208:223]
ds_read_b128 v[232:235], v248 offset:50208
s_waitcnt lgkmcnt(3)
v_mfma_f32_32x32x16_bf16 v[192:207], v[236:239], v[48:51], v[192:207]
v_mfma_f32_32x32x16_bf16 v[208:223], v[236:239], v[52:55], v[208:223]
ds_read_b128 v[236:239], v248 offset:50240
s_waitcnt lgkmcnt(3)
v_mfma_f32_32x32x16_bf16 v[192:207], v[244:247], v[56:59], v[192:207]
v_mfma_f32_32x32x16_bf16 v[208:223], v[244:247], v[60:63], v[208:223]
ds_read_b128 v[244:247], v248 offset:50272
s_waitcnt lgkmcnt(3)
v_mfma_f32_32x32x16_bf16 v[192:207], v[240:243], v[64:67], v[192:207]
v_mfma_f32_32x32x16_bf16 v[208:223], v[240:243], v[68:71], v[208:223]
ds_read_b128 v[240:243], v248 offset:50304
s_waitcnt lgkmcnt(3)
v_mfma_f32_32x32x16_bf16 v[192:207], v[232:235], v[72:75], v[192:207]
v_mfma_f32_32x32x16_bf16 v[208:223], v[232:235], v[76:79], v[208:223]
ds_read_b128 v[232:235], v248 offset:50336
s_waitcnt lgkmcnt(3)
v_mfma_f32_32x32x16_bf16 v[192:207], v[236:239], v[80:83], v[192:207]
v_mfma_f32_32x32x16_bf16 v[208:223], v[236:239], v[84:87], v[208:223]
ds_read_b128 v[236:239], v248 offset:50368
s_waitcnt lgkmcnt(3)
v_mfma_f32_32x32x16_bf16 v[192:207], v[244:247], v[88:91], v[192:207]
v_mfma_f32_32x32x16_bf16 v[208:223], v[244:247], v[92:95], v[208:223]
ds_read_b128 v[244:247], v248 offset:50400
s_waitcnt lgkmcnt(3)
v_mfma_f32_32x32x16_bf16 v[192:207], v[240:243], v[96:99], v[192:207]
v_mfma_f32_32x32x16_bf16 v[208:223], v[240:243], v[100:103], v[208:223]
ds_read2_b32 v[224:225], v253 offset0:0 offset1:2
ds_read2_b32 v[226:227], v253 offset0:4 offset1:6
ds_read2_b32 v[228:229], v253 offset0:8 offset1:10
ds_read2_b32 v[230:231], v253 offset0:12 offset1:14
s_waitcnt lgkmcnt(6)
v_mfma_f32_32x32x16_bf16 v[192:207], v[232:235], v[104:107], v[192:207]
v_mfma_f32_32x32x16_bf16 v[208:223], v[232:235], v[108:111], v[208:223]
ds_read2_b32 v[232:233], v253 offset0:16 offset1:18
ds_read2_b32 v[234:235], v253 offset0:20 offset1:22
s_waitcnt lgkmcnt(7)
v_mfma_f32_32x32x16_bf16 v[192:207], v[236:239], v[112:115], v[192:207]
v_mfma_f32_32x32x16_bf16 v[208:223], v[236:239], v[116:119], v[208:223]
ds_read2_b32 v[236:237], v253 offset0:24 offset1:26
ds_read2_b32 v[238:239], v253 offset0:28 offset1:30
s_waitcnt lgkmcnt(8)
v_mfma_f32_32x32x16_bf16 v[192:207], v[244:247], v[120:123], v[192:207]
v_mfma_f32_32x32x16_bf16 v[208:223], v[244:247], v[124:127], v[208:223]
ds_read2_b32 v[240:241], v253 offset0:32 offset1:34
ds_read2_b32 v[242:243], v253 offset0:36 offset1:38
s_setprio 0
s_nop 8
v_mul_f32 v208, s37, v208
v_mul_f32 v209, s37, v209
v_mul_f32 v210, s37, v210
v_mul_f32 v211, s37, v211
v_exp_f32 v208, v208
v_exp_f32 v209, v209
v_exp_f32 v210, v210
v_exp_f32 v211, v211
v_fma_f32 v208, v208, s38, s38
v_fma_f32 v209, v209, s38, s38
v_fma_f32 v210, v210, s38, s38
v_fma_f32 v211, v211, s38, s38
v_rcp_f32 v208, v208
v_rcp_f32 v209, v209
v_rcp_f32 v210, v210
v_rcp_f32 v211, v211
v_mul_f32 v192, v192, v208
v_mul_f32 v193, v193, v209
v_mul_f32 v194, v194, v210
v_mul_f32 v195, v195, v211
v_cvt_pk_bf16_f32 v208, v192, v193
v_cvt_pk_bf16_f32 v209, v194, v195
v_mul_f32 v212, s37, v212
v_mul_f32 v213, s37, v213
v_mul_f32 v214, s37, v214
v_mul_f32 v215, s37, v215
v_exp_f32 v212, v212
v_exp_f32 v213, v213
v_exp_f32 v214, v214
v_exp_f32 v215, v215
v_fma_f32 v212, v212, s38, s38
v_fma_f32 v213, v213, s38, s38
v_fma_f32 v214, v214, s38, s38
v_fma_f32 v215, v215, s38, s38
v_rcp_f32 v212, v212
v_rcp_f32 v213, v213
v_rcp_f32 v214, v214
v_rcp_f32 v215, v215
v_mul_f32 v196, v196, v212
v_mul_f32 v197, v197, v213
v_mul_f32 v198, v198, v214
v_mul_f32 v199, v199, v215
v_cvt_pk_bf16_f32 v210, v196, v197
v_cvt_pk_bf16_f32 v211, v198, v199
ds_write_b128 v249, v[208:211] offset:32
ds_read_b128 v[192:195], v250
ds_read_b128 v[212:215], v250 offset:1536
v_mul_f32 v216, s37, v216
v_mul_f32 v217, s37, v217
v_mul_f32 v218, s37, v218
v_mul_f32 v219, s37, v219
v_exp_f32 v216, v216
v_exp_f32 v217, v217
v_exp_f32 v218, v218
v_exp_f32 v219, v219
v_fma_f32 v216, v216, s38, s38
v_fma_f32 v217, v217, s38, s38
v_fma_f32 v218, v218, s38, s38
v_fma_f32 v219, v219, s38, s38
v_rcp_f32 v216, v216
v_rcp_f32 v217, v217
v_rcp_f32 v218, v218
v_rcp_f32 v219, v219
v_mul_f32 v200, v200, v216
v_mul_f32 v201, v201, v217
v_mul_f32 v202, v202, v218
v_mul_f32 v203, v203, v219
v_cvt_pk_bf16_f32 v244, v200, v201
v_cvt_pk_bf16_f32 v245, v202, v203
v_mul_f32 v220, s37, v220
v_mul_f32 v221, s37, v221
v_mul_f32 v222, s37, v222
v_mul_f32 v223, s37, v223
v_exp_f32 v220, v220
v_exp_f32 v221, v221
v_exp_f32 v222, v222
v_exp_f32 v223, v223
v_fma_f32 v220, v220, s38, s38
v_fma_f32 v221, v221, s38, s38
v_fma_f32 v222, v222, s38, s38
v_fma_f32 v223, v223, s38, s38
v_rcp_f32 v220, v220
v_rcp_f32 v221, v221
v_rcp_f32 v222, v222
v_rcp_f32 v223, v223
v_mul_f32 v204, v204, v220
v_mul_f32 v205, v205, v221
v_mul_f32 v206, v206, v222
v_mul_f32 v207, v207, v223
v_cvt_pk_bf16_f32 v246, v204, v205
v_cvt_pk_bf16_f32 v247, v206, v207
ds_write_b128 v249, v[244:247] offset:64
ds_read_b128 v[196:199], v250 offset:16
ds_read_b128 v[216:219], v250 offset:1552
ds_read_b128 v[200:203], v250 offset:32
ds_read_b128 v[220:223], v250 offset:1568
ds_write_b128 v249, v[244:247]
s_waitcnt lgkmcnt(0)
s_setprio 3
v_mfma_f32_4x4x4_16b_bf16 v[204:207], v[224:225], v[192:193], 0
v_mfma_f32_4x4x4_16b_bf16 v[208:211], v[224:225], v[194:195], 0
v_mfma_f32_4x4x4_16b_bf16 v[244:247], v[234:235], v[212:213], 0
v_mfma_f32_4x4x4_16b_bf16 v[204:207], v[226:227], v[194:195], v[204:207]
v_mfma_f32_4x4x4_16b_bf16 v[208:211], v[226:227], v[196:197], v[208:211]
v_mfma_f32_4x4x4_16b_bf16 v[224:227], v[234:235], v[214:215], 0
v_mfma_f32_4x4x4_16b_bf16 v[244:247], v[236:237], v[214:215], v[244:247]
v_mfma_f32_4x4x4_16b_bf16 v[204:207], v[228:229], v[196:197], v[204:207]
v_mfma_f32_4x4x4_16b_bf16 v[224:227], v[236:237], v[216:217], v[224:227]
v_mfma_f32_4x4x4_16b_bf16 v[208:211], v[228:229], v[198:199], v[208:211]
v_mfma_f32_4x4x4_16b_bf16 v[244:247], v[238:239], v[216:217], v[244:247]
v_mfma_f32_4x4x4_16b_bf16 v[204:207], v[230:231], v[198:199], v[204:207]
v_mfma_f32_4x4x4_16b_bf16 v[224:227], v[238:239], v[218:219], v[224:227]
v_mfma_f32_4x4x4_16b_bf16 v[208:211], v[230:231], v[200:201], v[208:211]
v_mfma_f32_4x4x4_16b_bf16 v[244:247], v[240:241], v[218:219], v[244:247]
v_mfma_f32_4x4x4_16b_bf16 v[224:227], v[240:241], v[220:221], v[224:227]
v_mfma_f32_4x4x4_16b_bf16 v[204:207], v[232:233], v[200:201], v[204:207]
v_mfma_f32_4x4x4_16b_bf16 v[208:211], v[232:233], v[202:203], v[208:211]
v_mfma_f32_4x4x4_16b_bf16 v[244:247], v[242:243], v[220:221], v[244:247]
v_mfma_f32_4x4x4_16b_bf16 v[224:227], v[242:243], v[222:223], v[224:227]
s_setprio 0
s_nop 0
v_exp_f32 v192, v204
v_exp_f32 v193, v205
v_exp_f32 v194, v206
v_exp_f32 v195, v207
v_fma_f32 v192, v192, s37, s37
v_fma_f32 v193, v193, s37, s37
v_fma_f32 v194, v194, s37, s37
v_fma_f32 v195, v195, s37, s37
v_rcp_f32 v192, v192
v_rcp_f32 v193, v193
v_rcp_f32 v194, v194
v_rcp_f32 v195, v195
v_mul_f32 v204, v204, v192
v_mul_f32 v205, v205, v193
v_mul_f32 v206, v206, v194
v_mul_f32 v207, v207, v195
v_cvt_pk_bf16_f32 v204, v204, v205
v_cvt_pk_bf16_f32 v205, v206, v207
v_exp_f32 v196, v208
v_exp_f32 v197, v209
v_exp_f32 v198, v210
v_exp_f32 v199, v211
v_fma_f32 v196, v196, s37, s37
v_fma_f32 v197, v197, s37, s37
v_fma_f32 v198, v198, s37, s37
v_fma_f32 v199, v199, s37, s37
v_rcp_f32 v196, v196
v_rcp_f32 v197, v197
v_rcp_f32 v198, v198
v_rcp_f32 v199, v199
v_mul_f32 v208, v208, v196
v_mul_f32 v209, v209, v197
v_mul_f32 v210, v210, v198
v_mul_f32 v211, v211, v199
v_cvt_pk_bf16_f32 v206, v208, v209
v_cvt_pk_bf16_f32 v207, v210, v211
ds_write_b128 v251, v[204:207]
v_exp_f32 v192, v244
v_exp_f32 v193, v245
v_exp_f32 v194, v246
v_exp_f32 v195, v247
v_fma_f32 v192, v192, s37, s37
v_fma_f32 v193, v193, s37, s37
v_fma_f32 v194, v194, s37, s37
v_fma_f32 v195, v195, s37, s37
v_rcp_f32 v192, v192
v_rcp_f32 v193, v193
v_rcp_f32 v194, v194
v_rcp_f32 v195, v195
v_mul_f32 v244, v244, v192
v_mul_f32 v245, v245, v193
v_mul_f32 v246, v246, v194
v_mul_f32 v247, v247, v195
v_cvt_pk_bf16_f32 v244, v244, v245
v_cvt_pk_bf16_f32 v245, v246, v247
v_exp_f32 v196, v224
v_exp_f32 v197, v225
v_exp_f32 v198, v226
v_exp_f32 v199, v227
v_fma_f32 v196, v196, s37, s37
v_fma_f32 v197, v197, s37, s37
v_fma_f32 v198, v198, s37, s37
v_fma_f32 v199, v199, s37, s37
v_rcp_f32 v196, v196
v_rcp_f32 v197, v197
v_rcp_f32 v198, v198
v_rcp_f32 v199, v199
v_mul_f32 v224, v224, v196
v_mul_f32 v225, v225, v197
v_mul_f32 v226, v226, v198
v_mul_f32 v227, v227, v199
v_cvt_pk_bf16_f32 v246, v224, v225
v_cvt_pk_bf16_f32 v247, v226, v227
ds_write_b128 v251, v[244:247] offset:8192
s_waitcnt lgkmcnt(0)
s_barrier
s_setprio 2
ds_read_b64_tr_b16 v[200:201], v252
ds_read_b64_tr_b16 v[202:203], v252 offset:256
ds_read_b64_tr_b16 v[212:213], v252 offset:1024
ds_read_b64_tr_b16 v[214:215], v252 offset:1280
ds_read_b64_tr_b16 v[216:217], v252 offset:2048
ds_read_b64_tr_b16 v[218:219], v252 offset:2304
ds_read_b64_tr_b16 v[220:221], v252 offset:3072
ds_read_b64_tr_b16 v[222:223], v252 offset:3328
ds_read_b64_tr_b16 v[204:205], v252 offset:4096
ds_read_b64_tr_b16 v[206:207], v252 offset:4352
ds_read_b64_tr_b16 v[208:209], v252 offset:5120
ds_read_b64_tr_b16 v[210:211], v252 offset:5376
s_waitcnt lgkmcnt(10)
v_mfma_f32_32x32x16_bf16 v[224:239], v[128:131], v[200:203], 0
ds_read_b64_tr_b16 v[192:193], v252 offset:6144
ds_read_b64_tr_b16 v[194:195], v252 offset:6400
s_waitcnt lgkmcnt(10)
v_mfma_f32_32x32x16_bf16 v[224:239], v[132:135], v[212:215], v[224:239]
ds_read_b64_tr_b16 v[196:197], v252 offset:7168
ds_read_b64_tr_b16 v[198:199], v252 offset:7424
s_waitcnt lgkmcnt(10)
v_mfma_f32_32x32x16_bf16 v[224:239], v[136:139], v[216:219], v[224:239]
ds_read_b64_tr_b16 v[200:201], v252 offset:8192
ds_read_b64_tr_b16 v[202:203], v252 offset:8448
s_waitcnt lgkmcnt(10)
v_mfma_f32_32x32x16_bf16 v[224:239], v[140:143], v[220:223], v[224:239]
ds_read_b64_tr_b16 v[212:213], v252 offset:9216
ds_read_b64_tr_b16 v[214:215], v252 offset:9472
s_waitcnt lgkmcnt(10)
v_mfma_f32_32x32x16_bf16 v[224:239], v[144:147], v[204:207], v[224:239]
ds_read_b64_tr_b16 v[216:217], v252 offset:10240
ds_read_b64_tr_b16 v[218:219], v252 offset:10496
s_waitcnt lgkmcnt(10)
v_mfma_f32_32x32x16_bf16 v[224:239], v[148:151], v[208:211], v[224:239]
ds_read_b64_tr_b16 v[220:221], v252 offset:11264
ds_read_b64_tr_b16 v[222:223], v252 offset:11520
s_waitcnt lgkmcnt(10)
v_mfma_f32_32x32x16_bf16 v[224:239], v[152:155], v[192:195], v[224:239]
ds_read_b64_tr_b16 v[204:205], v252 offset:12288
ds_read_b64_tr_b16 v[206:207], v252 offset:12544
s_waitcnt lgkmcnt(10)
v_mfma_f32_32x32x16_bf16 v[224:239], v[156:159], v[196:199], v[224:239]
ds_read_b64_tr_b16 v[208:209], v252 offset:13312
ds_read_b64_tr_b16 v[210:211], v252 offset:13568
s_waitcnt lgkmcnt(10)
v_mfma_f32_32x32x16_bf16 v[224:239], v[160:163], v[200:203], v[224:239]
ds_read_b64_tr_b16 v[192:193], v252 offset:14336
ds_read_b64_tr_b16 v[194:195], v252 offset:14592
s_waitcnt lgkmcnt(10)
v_mfma_f32_32x32x16_bf16 v[224:239], v[164:167], v[212:215], v[224:239]
ds_read_b64_tr_b16 v[196:197], v252 offset:15360
ds_read_b64_tr_b16 v[198:199], v252 offset:15616
s_waitcnt lgkmcnt(10)
v_mfma_f32_32x32x16_bf16 v[224:239], v[168:171], v[216:219], v[224:239]
s_waitcnt lgkmcnt(8)
v_mfma_f32_32x32x16_bf16 v[224:239], v[172:175], v[220:223], v[224:239]
s_waitcnt lgkmcnt(6)
v_mfma_f32_32x32x16_bf16 v[224:239], v[176:179], v[204:207], v[224:239]
ds_read_b128 v[240:243], v248
s_waitcnt lgkmcnt(5)
v_mfma_f32_32x32x16_bf16 v[224:239], v[180:183], v[208:211], v[224:239]
ds_read_b128 v[244:247], v248 offset:32
s_waitcnt lgkmcnt(4)
v_mfma_f32_32x32x16_bf16 v[224:239], v[184:187], v[192:195], v[224:239]
s_waitcnt lgkmcnt(2)
v_mfma_f32_32x32x16_bf16 v[224:239], v[188:191], v[196:199], v[224:239]
s_waitcnt lgkmcnt(1)
v_mfma_f32_32x32x16_bf16 v[192:207], v[240:243], v[0:3], 0
v_mfma_f32_32x32x16_bf16 v[208:223], v[240:243], v[4:7], 0
ds_read_b128 v[240:243], v248 offset:64
s_waitcnt lgkmcnt(1)
v_mfma_f32_32x32x16_bf16 v[192:207], v[244:247], v[8:11], v[192:207]
v_mfma_f32_32x32x16_bf16 v[208:223], v[244:247], v[12:15], v[208:223]
ds_read_b128 v[244:247], v248 offset:96
s_nop 3
v_cvt_pk_bf16_f32 v224, v224, v225
v_cvt_pk_bf16_f32 v225, v226, v227
v_cvt_pk_bf16_f32 v226, v228, v229
v_cvt_pk_bf16_f32 v227, v230, v231
s_waitcnt lgkmcnt(1)
v_mfma_f32_32x32x16_bf16 v[192:207], v[240:243], v[16:19], v[192:207]
v_mfma_f32_32x32x16_bf16 v[208:223], v[240:243], v[20:23], v[208:223]
ds_read_b128 v[240:243], v248 offset:128
v_cvt_pk_bf16_f32 v228, v232, v233
v_cvt_pk_bf16_f32 v229, v234, v235
v_cvt_pk_bf16_f32 v230, v236, v237
v_cvt_pk_bf16_f32 v231, v238, v239
v_permlane16_swap_b32 v224, v228
v_permlane16_swap_b32 v225, v229
v_permlane16_swap_b32 v226, v230
v_permlane16_swap_b32 v227, v231
s_mov_b32 s42, 32768
buffer_store_dwordx4 v[224:227], v254, s[32:35], s42 offen sc0 sc1 nt
s_mov_b32 s43, 40960
buffer_store_dwordx4 v[228:231], v254, s[32:35], s43 offen sc0 sc1 nt
ds_read_b128 v[232:235], v248 offset:160
ds_read_b128 v[236:239], v248 offset:192
s_waitcnt lgkmcnt(3)
v_mfma_f32_32x32x16_bf16 v[192:207], v[244:247], v[24:27], v[192:207]
v_mfma_f32_32x32x16_bf16 v[208:223], v[244:247], v[28:31], v[208:223]
ds_read_b128 v[244:247], v248 offset:224
s_waitcnt lgkmcnt(3)
v_mfma_f32_32x32x16_bf16 v[192:207], v[240:243], v[32:35], v[192:207]
v_mfma_f32_32x32x16_bf16 v[208:223], v[240:243], v[36:39], v[208:223]
ds_read_b128 v[240:243], v248 offset:256
s_waitcnt lgkmcnt(3)
v_mfma_f32_32x32x16_bf16 v[192:207], v[232:235], v[40:43], v[192:207]
v_mfma_f32_32x32x16_bf16 v[208:223], v[232:235], v[44:47], v[208:223]
ds_read_b128 v[232:235], v248 offset:288
s_waitcnt lgkmcnt(3)
v_mfma_f32_32x32x16_bf16 v[192:207], v[236:239], v[48:51], v[192:207]
v_mfma_f32_32x32x16_bf16 v[208:223], v[236:239], v[52:55], v[208:223]
ds_read_b128 v[236:239], v248 offset:320
s_waitcnt lgkmcnt(3)
v_mfma_f32_32x32x16_bf16 v[192:207], v[244:247], v[56:59], v[192:207]
v_mfma_f32_32x32x16_bf16 v[208:223], v[244:247], v[60:63], v[208:223]
ds_read_b128 v[244:247], v248 offset:352
s_waitcnt lgkmcnt(3)
v_mfma_f32_32x32x16_bf16 v[192:207], v[240:243], v[64:67], v[192:207]
v_mfma_f32_32x32x16_bf16 v[208:223], v[240:243], v[68:71], v[208:223]
ds_read_b128 v[240:243], v248 offset:384
s_waitcnt lgkmcnt(3)
v_mfma_f32_32x32x16_bf16 v[192:207], v[232:235], v[72:75], v[192:207]
v_mfma_f32_32x32x16_bf16 v[208:223], v[232:235], v[76:79], v[208:223]
ds_read_b128 v[232:235], v248 offset:416
s_waitcnt lgkmcnt(3)
v_mfma_f32_32x32x16_bf16 v[192:207], v[236:239], v[80:83], v[192:207]
v_mfma_f32_32x32x16_bf16 v[208:223], v[236:239], v[84:87], v[208:223]
ds_read_b128 v[236:239], v248 offset:448
s_waitcnt lgkmcnt(3)
v_mfma_f32_32x32x16_bf16 v[192:207], v[244:247], v[88:91], v[192:207]
v_mfma_f32_32x32x16_bf16 v[208:223], v[244:247], v[92:95], v[208:223]
ds_read_b128 v[244:247], v248 offset:480
s_waitcnt lgkmcnt(3)
v_mfma_f32_32x32x16_bf16 v[192:207], v[240:243], v[96:99], v[192:207]
v_mfma_f32_32x32x16_bf16 v[208:223], v[240:243], v[100:103], v[208:223]
ds_read2_b32 v[224:225], v253 offset0:0 offset1:2
ds_read2_b32 v[226:227], v253 offset0:4 offset1:6
ds_read2_b32 v[228:229], v253 offset0:8 offset1:10
ds_read2_b32 v[230:231], v253 offset0:12 offset1:14
s_waitcnt lgkmcnt(6)
v_mfma_f32_32x32x16_bf16 v[192:207], v[232:235], v[104:107], v[192:207]
v_mfma_f32_32x32x16_bf16 v[208:223], v[232:235], v[108:111], v[208:223]
ds_read2_b32 v[232:233], v253 offset0:16 offset1:18
ds_read2_b32 v[234:235], v253 offset0:20 offset1:22
s_waitcnt lgkmcnt(7)
v_mfma_f32_32x32x16_bf16 v[192:207], v[236:239], v[112:115], v[192:207]
v_mfma_f32_32x32x16_bf16 v[208:223], v[236:239], v[116:119], v[208:223]
ds_read2_b32 v[236:237], v253 offset0:24 offset1:26
ds_read2_b32 v[238:239], v253 offset0:28 offset1:30
s_waitcnt lgkmcnt(8)
v_mfma_f32_32x32x16_bf16 v[192:207], v[244:247], v[120:123], v[192:207]
v_mfma_f32_32x32x16_bf16 v[208:223], v[244:247], v[124:127], v[208:223]
ds_read2_b32 v[240:241], v253 offset0:32 offset1:34
ds_read2_b32 v[242:243], v253 offset0:36 offset1:38
s_setprio 0
s_nop 8
v_mul_f32 v208, s37, v208
v_mul_f32 v209, s37, v209
v_mul_f32 v210, s37, v210
v_mul_f32 v211, s37, v211
v_exp_f32 v208, v208
v_exp_f32 v209, v209
v_exp_f32 v210, v210
v_exp_f32 v211, v211
v_fma_f32 v208, v208, s38, s38
v_fma_f32 v209, v209, s38, s38
v_fma_f32 v210, v210, s38, s38
v_fma_f32 v211, v211, s38, s38
v_rcp_f32 v208, v208
v_rcp_f32 v209, v209
v_rcp_f32 v210, v210
v_rcp_f32 v211, v211
v_mul_f32 v192, v192, v208
v_mul_f32 v193, v193, v209
v_mul_f32 v194, v194, v210
v_mul_f32 v195, v195, v211
v_cvt_pk_bf16_f32 v208, v192, v193
v_cvt_pk_bf16_f32 v209, v194, v195
v_mul_f32 v212, s37, v212
v_mul_f32 v213, s37, v213
v_mul_f32 v214, s37, v214
v_mul_f32 v215, s37, v215
v_exp_f32 v212, v212
v_exp_f32 v213, v213
v_exp_f32 v214, v214
v_exp_f32 v215, v215
v_fma_f32 v212, v212, s38, s38
v_fma_f32 v213, v213, s38, s38
v_fma_f32 v214, v214, s38, s38
v_fma_f32 v215, v215, s38, s38
v_rcp_f32 v212, v212
v_rcp_f32 v213, v213
v_rcp_f32 v214, v214
v_rcp_f32 v215, v215
v_mul_f32 v196, v196, v212
v_mul_f32 v197, v197, v213
v_mul_f32 v198, v198, v214
v_mul_f32 v199, v199, v215
v_cvt_pk_bf16_f32 v210, v196, v197
v_cvt_pk_bf16_f32 v211, v198, v199
ds_write_b128 v249, v[208:211] offset:32
ds_read_b128 v[192:195], v250
ds_read_b128 v[212:215], v250 offset:1536
v_mul_f32 v216, s37, v216
v_mul_f32 v217, s37, v217
v_mul_f32 v218, s37, v218
v_mul_f32 v219, s37, v219
v_exp_f32 v216, v216
v_exp_f32 v217, v217
v_exp_f32 v218, v218
v_exp_f32 v219, v219
v_fma_f32 v216, v216, s38, s38
v_fma_f32 v217, v217, s38, s38
v_fma_f32 v218, v218, s38, s38
v_fma_f32 v219, v219, s38, s38
v_rcp_f32 v216, v216
v_rcp_f32 v217, v217
v_rcp_f32 v218, v218
v_rcp_f32 v219, v219
v_mul_f32 v200, v200, v216
v_mul_f32 v201, v201, v217
v_mul_f32 v202, v202, v218
v_mul_f32 v203, v203, v219
v_cvt_pk_bf16_f32 v244, v200, v201
v_cvt_pk_bf16_f32 v245, v202, v203
v_mul_f32 v220, s37, v220
v_mul_f32 v221, s37, v221
v_mul_f32 v222, s37, v222
v_mul_f32 v223, s37, v223
v_exp_f32 v220, v220
v_exp_f32 v221, v221
v_exp_f32 v222, v222
v_exp_f32 v223, v223
v_fma_f32 v220, v220, s38, s38
v_fma_f32 v221, v221, s38, s38
v_fma_f32 v222, v222, s38, s38
v_fma_f32 v223, v223, s38, s38
v_rcp_f32 v220, v220
v_rcp_f32 v221, v221
v_rcp_f32 v222, v222
v_rcp_f32 v223, v223
v_mul_f32 v204, v204, v220
v_mul_f32 v205, v205, v221
v_mul_f32 v206, v206, v222
v_mul_f32 v207, v207, v223
v_cvt_pk_bf16_f32 v246, v204, v205
v_cvt_pk_bf16_f32 v247, v206, v207
ds_write_b128 v249, v[244:247] offset:64
ds_read_b128 v[196:199], v250 offset:16
ds_read_b128 v[216:219], v250 offset:1552
ds_read_b128 v[200:203], v250 offset:32
ds_read_b128 v[220:223], v250 offset:1568
s_waitcnt lgkmcnt(0)
s_setprio 3
v_mfma_f32_4x4x4_16b_bf16 v[204:207], v[224:225], v[192:193], 0
v_mfma_f32_4x4x4_16b_bf16 v[208:211], v[224:225], v[194:195], 0
v_mfma_f32_4x4x4_16b_bf16 v[244:247], v[234:235], v[212:213], 0
v_mfma_f32_4x4x4_16b_bf16 v[204:207], v[226:227], v[194:195], v[204:207]
v_mfma_f32_4x4x4_16b_bf16 v[208:211], v[226:227], v[196:197], v[208:211]
v_mfma_f32_4x4x4_16b_bf16 v[224:227], v[234:235], v[214:215], 0
v_mfma_f32_4x4x4_16b_bf16 v[244:247], v[236:237], v[214:215], v[244:247]
v_mfma_f32_4x4x4_16b_bf16 v[204:207], v[228:229], v[196:197], v[204:207]
v_mfma_f32_4x4x4_16b_bf16 v[224:227], v[236:237], v[216:217], v[224:227]
v_mfma_f32_4x4x4_16b_bf16 v[208:211], v[228:229], v[198:199], v[208:211]
v_mfma_f32_4x4x4_16b_bf16 v[244:247], v[238:239], v[216:217], v[244:247]
v_mfma_f32_4x4x4_16b_bf16 v[204:207], v[230:231], v[198:199], v[204:207]
v_mfma_f32_4x4x4_16b_bf16 v[224:227], v[238:239], v[218:219], v[224:227]
v_mfma_f32_4x4x4_16b_bf16 v[208:211], v[230:231], v[200:201], v[208:211]
v_mfma_f32_4x4x4_16b_bf16 v[244:247], v[240:241], v[218:219], v[244:247]
v_mfma_f32_4x4x4_16b_bf16 v[224:227], v[240:241], v[220:221], v[224:227]
v_mfma_f32_4x4x4_16b_bf16 v[204:207], v[232:233], v[200:201], v[204:207]
v_mfma_f32_4x4x4_16b_bf16 v[208:211], v[232:233], v[202:203], v[208:211]
v_mfma_f32_4x4x4_16b_bf16 v[244:247], v[242:243], v[220:221], v[244:247]
v_mfma_f32_4x4x4_16b_bf16 v[224:227], v[242:243], v[222:223], v[224:227]
s_setprio 0
s_nop 0
v_exp_f32 v192, v204
v_exp_f32 v193, v205
v_exp_f32 v194, v206
v_exp_f32 v195, v207
v_fma_f32 v192, v192, s37, s37
v_fma_f32 v193, v193, s37, s37
v_fma_f32 v194, v194, s37, s37
v_fma_f32 v195, v195, s37, s37
v_rcp_f32 v192, v192
v_rcp_f32 v193, v193
v_rcp_f32 v194, v194
v_rcp_f32 v195, v195
v_mul_f32 v204, v204, v192
v_mul_f32 v205, v205, v193
v_mul_f32 v206, v206, v194
v_mul_f32 v207, v207, v195
v_cvt_pk_bf16_f32 v204, v204, v205
v_cvt_pk_bf16_f32 v205, v206, v207
v_exp_f32 v196, v208
v_exp_f32 v197, v209
v_exp_f32 v198, v210
v_exp_f32 v199, v211
v_fma_f32 v196, v196, s37, s37
v_fma_f32 v197, v197, s37, s37
v_fma_f32 v198, v198, s37, s37
v_fma_f32 v199, v199, s37, s37
v_rcp_f32 v196, v196
v_rcp_f32 v197, v197
v_rcp_f32 v198, v198
v_rcp_f32 v199, v199
v_mul_f32 v208, v208, v196
v_mul_f32 v209, v209, v197
v_mul_f32 v210, v210, v198
v_mul_f32 v211, v211, v199
v_cvt_pk_bf16_f32 v206, v208, v209
v_cvt_pk_bf16_f32 v207, v210, v211
ds_write_b128 v251, v[204:207] offset:16384
v_exp_f32 v192, v244
v_exp_f32 v193, v245
v_exp_f32 v194, v246
v_exp_f32 v195, v247
v_fma_f32 v192, v192, s37, s37
v_fma_f32 v193, v193, s37, s37
v_fma_f32 v194, v194, s37, s37
v_fma_f32 v195, v195, s37, s37
v_rcp_f32 v192, v192
v_rcp_f32 v193, v193
v_rcp_f32 v194, v194
v_rcp_f32 v195, v195
v_mul_f32 v244, v244, v192
v_mul_f32 v245, v245, v193
v_mul_f32 v246, v246, v194
v_mul_f32 v247, v247, v195
v_cvt_pk_bf16_f32 v244, v244, v245
v_cvt_pk_bf16_f32 v245, v246, v247
v_exp_f32 v196, v224
v_exp_f32 v197, v225
v_exp_f32 v198, v226
v_exp_f32 v199, v227
v_fma_f32 v196, v196, s37, s37
v_fma_f32 v197, v197, s37, s37
v_fma_f32 v198, v198, s37, s37
v_fma_f32 v199, v199, s37, s37
v_rcp_f32 v196, v196
v_rcp_f32 v197, v197
v_rcp_f32 v198, v198
v_rcp_f32 v199, v199
v_mul_f32 v224, v224, v196
v_mul_f32 v225, v225, v197
v_mul_f32 v226, v226, v198
v_mul_f32 v227, v227, v199
v_cvt_pk_bf16_f32 v246, v224, v225
v_cvt_pk_bf16_f32 v247, v226, v227
ds_write_b128 v251, v[244:247] offset:24576
s_waitcnt lgkmcnt(0)
s_barrier
s_setprio 2
ds_read_b64_tr_b16 v[200:201], v252 offset:16384
ds_read_b64_tr_b16 v[202:203], v252 offset:16640
ds_read_b64_tr_b16 v[212:213], v252 offset:17408
ds_read_b64_tr_b16 v[214:215], v252 offset:17664
ds_read_b64_tr_b16 v[216:217], v252 offset:18432
ds_read_b64_tr_b16 v[218:219], v252 offset:18688
ds_read_b64_tr_b16 v[220:221], v252 offset:19456
ds_read_b64_tr_b16 v[222:223], v252 offset:19712
ds_read_b64_tr_b16 v[204:205], v252 offset:20480
ds_read_b64_tr_b16 v[206:207], v252 offset:20736
ds_read_b64_tr_b16 v[208:209], v252 offset:21504
ds_read_b64_tr_b16 v[210:211], v252 offset:21760
s_waitcnt lgkmcnt(10)
v_mfma_f32_32x32x16_bf16 v[224:239], v[128:131], v[200:203], 0
ds_read_b64_tr_b16 v[192:193], v252 offset:22528
ds_read_b64_tr_b16 v[194:195], v252 offset:22784
s_waitcnt lgkmcnt(10)
v_mfma_f32_32x32x16_bf16 v[224:239], v[132:135], v[212:215], v[224:239]
ds_read_b64_tr_b16 v[196:197], v252 offset:23552
ds_read_b64_tr_b16 v[198:199], v252 offset:23808
s_waitcnt lgkmcnt(10)
v_mfma_f32_32x32x16_bf16 v[224:239], v[136:139], v[216:219], v[224:239]
ds_read_b64_tr_b16 v[200:201], v252 offset:24576
ds_read_b64_tr_b16 v[202:203], v252 offset:24832
s_waitcnt lgkmcnt(10)
v_mfma_f32_32x32x16_bf16 v[224:239], v[140:143], v[220:223], v[224:239]
ds_read_b64_tr_b16 v[212:213], v252 offset:25600
ds_read_b64_tr_b16 v[214:215], v252 offset:25856
s_waitcnt lgkmcnt(10)
v_mfma_f32_32x32x16_bf16 v[224:239], v[144:147], v[204:207], v[224:239]
ds_read_b64_tr_b16 v[216:217], v252 offset:26624
ds_read_b64_tr_b16 v[218:219], v252 offset:26880
s_waitcnt lgkmcnt(10)
v_mfma_f32_32x32x16_bf16 v[224:239], v[148:151], v[208:211], v[224:239]
ds_read_b64_tr_b16 v[220:221], v252 offset:27648
ds_read_b64_tr_b16 v[222:223], v252 offset:27904
s_waitcnt lgkmcnt(10)
v_mfma_f32_32x32x16_bf16 v[224:239], v[152:155], v[192:195], v[224:239]
ds_read_b64_tr_b16 v[204:205], v252 offset:28672
ds_read_b64_tr_b16 v[206:207], v252 offset:28928
s_waitcnt lgkmcnt(10)
v_mfma_f32_32x32x16_bf16 v[224:239], v[156:159], v[196:199], v[224:239]
ds_read_b64_tr_b16 v[208:209], v252 offset:29696
ds_read_b64_tr_b16 v[210:211], v252 offset:29952
s_waitcnt lgkmcnt(10)
v_mfma_f32_32x32x16_bf16 v[224:239], v[160:163], v[200:203], v[224:239]
ds_read_b64_tr_b16 v[192:193], v252 offset:30720
ds_read_b64_tr_b16 v[194:195], v252 offset:30976
s_waitcnt lgkmcnt(10)
v_mfma_f32_32x32x16_bf16 v[224:239], v[164:167], v[212:215], v[224:239]
ds_read_b64_tr_b16 v[196:197], v252 offset:31744
ds_read_b64_tr_b16 v[198:199], v252 offset:32000
s_waitcnt lgkmcnt(10)
v_mfma_f32_32x32x16_bf16 v[224:239], v[168:171], v[216:219], v[224:239]
s_waitcnt lgkmcnt(8)
v_mfma_f32_32x32x16_bf16 v[224:239], v[172:175], v[220:223], v[224:239]
s_waitcnt lgkmcnt(6)
v_mfma_f32_32x32x16_bf16 v[224:239], v[176:179], v[204:207], v[224:239]
s_waitcnt lgkmcnt(4)
v_mfma_f32_32x32x16_bf16 v[224:239], v[180:183], v[208:211], v[224:239]
s_waitcnt lgkmcnt(2)
v_mfma_f32_32x32x16_bf16 v[224:239], v[184:187], v[192:195], v[224:239]
s_waitcnt lgkmcnt(0)
v_mfma_f32_32x32x16_bf16 v[224:239], v[188:191], v[196:199], v[224:239]
s_nop 11
v_cvt_pk_bf16_f32 v224, v224, v225
v_cvt_pk_bf16_f32 v225, v226, v227
v_cvt_pk_bf16_f32 v226, v228, v229
v_cvt_pk_bf16_f32 v227, v230, v231
v_cvt_pk_bf16_f32 v228, v232, v233
v_cvt_pk_bf16_f32 v229, v234, v235
v_cvt_pk_bf16_f32 v230, v236, v237
v_cvt_pk_bf16_f32 v231, v238, v239
v_permlane16_swap_b32 v224, v228
v_permlane16_swap_b32 v225, v229
v_permlane16_swap_b32 v226, v230
v_permlane16_swap_b32 v227, v231
s_mov_b32 s44, 49152
buffer_store_dwordx4 v[224:227], v254, s[32:35], s44 offen sc0 sc1 nt
s_mov_b32 s42, 57344
buffer_store_dwordx4 v[228:231], v254, s[32:35], s42 offen sc0 sc1 nt
s_endpgm
L_done:
s_endpgm
L_end:
.section .rodata,"a"
.p2align 6
.amdhsa_kernel standalone__conformer_conv_module__speech_kernel
  .amdhsa_next_free_vgpr 256
  .amdhsa_next_free_sgpr 102
  .amdhsa_accum_offset 256
  .amdhsa_group_segment_fixed_size 0
  .amdhsa_kernarg_size 56
  .amdhsa_user_sgpr_count 2
  .amdhsa_user_sgpr_kernarg_segment_ptr 1
  .amdhsa_system_sgpr_workgroup_id_x 1
.end_amdhsa_kernel
```
